```python
import torch

def _softmax(x, axis=-1):
    return torch.softmax(x, dim=axis)
def _gelu(x):
    return torch.nn.functional.gelu(x, approximate="tanh")
def _silu(x):
    return torch.nn.functional.silu(x)
def _sigmoid(x):
    return torch.sigmoid(x)
def _layernorm(x, axis=-1, eps=1e-5):
    m = x.mean(dim=axis, keepdim=True)
    v = x.var(dim=axis, keepdim=True, unbiased=False)
    return (x - m) / torch.sqrt(v + eps)
def _scatter_add(tgt, idx, src, axis=0):
    return tgt.clone().index_add_(axis, idx, src)
def _segment_sum(src, seg, n):
    out = torch.zeros((n,) + src.shape[1:], dtype=src.dtype)
    return out.index_add_(0, seg, src)
def _pad(x, pw):
    flat = tuple(v for pair in reversed(pw) for v in pair)
    return torch.nn.functional.pad(x, flat)

kernel_name = 'standalone__linear_attn_block__prompt'

def setup_inputs():

    _w = (lambda a: (lambda t: t.to(torch.bfloat16) if t.is_floating_point() else t)(torch.as_tensor(a)))
    B, S, D = 1, 2048, 640
    return {
        "x": _w((lambda *s: torch.randn(*s, dtype=torch.bfloat16) * 0.05)(B, S, D)),
        "wqkv": _w((lambda *s: torch.randn(*s, dtype=torch.bfloat16) * 0.4)(D, 3 * D)),
        "wo": _w((lambda *s: torch.randn(*s, dtype=torch.bfloat16) * 0.05)(D, D)),
    }

def reference(x, wqkv, wo):
    B, S, D = x.shape
    H = 32; Dh = D // H
    qkv = (lambda x, *d: x.permute(*d))((x @ wqkv).reshape(B, S, 3, H, Dh), 2, 0, 3, 1, 4)
    q, k, v = qkv[0], qkv[1], qkv[2]
    phi = lambda t: torch.where(t > 0, t + 1, torch.exp(t)) + 1e-6
    pq, pk = phi(q), phi(k)
    kv = torch.einsum("bhsd,bhse->bhde", pk, v)
    z = torch.einsum("bhsd->bhd", pk)
    num = torch.einsum("bhqd,bhde->bhqe", pq, kv)
    den = torch.einsum("bhqd,bhd->bhq", pq, z)[..., None] + 1e-6
    o = num / den
    return (lambda x, *d: x.permute(*d))(o, 0, 2, 1, 3).reshape(B, S, D) @ wo
```

```asm
; @launch kernel=k1_kernel grid=(256,1,1) block=(512,1,1) lds=163840
; @launch kernel=k2_kernel grid=(256,1,1) block=(512,1,1) lds=8192
; @launch kernel=k3_kernel grid=(256,1,1) block=(256,1,1) lds=163840
.amdgcn_target "amdgcn-amd-amdhsa--gfx950"
.text
.p2align 8
k1_kernel:
    s_cmp_ge_u32 s2, 256
    s_cbranch_scc1 K1_END
    s_load_dwordx2 s[4:5], s[0:1], 0
    s_load_dwordx2 s[6:7], s[0:1], 8
    s_load_dwordx2 s[8:9], s[0:1], 40
    s_and_b32 s30, s2, 7
    s_lshr_b32 s31, s2, 3
    s_lshr_b32 s25, s30, 1
    s_lshl_b32 s25, s25, 2
    s_and_b32 s32, s31, 3
    s_add_u32 s25, s25, s32
    s_and_b32 s26, s30, 1
    s_lshl_b32 s26, s26, 3
    s_lshr_b32 s32, s31, 2
    s_add_u32 s26, s26, s32
    v_lshrrev_b32 v2, 6, v0
    v_and_b32 v1, 63, v0
    s_nop 0
    v_readfirstlane_b32 s24, v2
    v_lshrrev_b32 v2, 3, v1
    v_mul_u32_u24 v2, 1280, v2
    v_lshrrev_b32 v3, 4, v1
    v_and_b32 v8, 7, v1
    v_xor_b32 v9, v8, v3
    v_lshl_add_u32 v4, v9, 4, v2
    v_xor_b32 v9, 4, v9
    v_lshl_add_u32 v5, v9, 4, v2
    v_mul_u32_u24 v2, 3840, v3
    v_and_b32 v8, 15, v1
    v_lshlrev_b32 v9, 1, v3
    v_xor_b32 v8, v8, v9
    s_and_b32 s30, s24, 1
    s_lshl_b32 s30, s30, 3
    v_xor_b32 v10, s30, v8
    v_min_u32 v10, 14, v10
    v_mul_u32_u24 v11, 52, v10
    v_lshrrev_b32 v11, 8, v11
    v_mul_u32_u24 v11, 1200, v11
    v_lshl_add_u32 v11, v10, 4, v11
    v_add_u32 v6, v11, v2
    s_and_b32 s30, s26, 1
    s_mul_i32 s30, s30, 80
    s_sub_u32 s31, 80, s30
    v_cmp_gt_u32 vcc, 5, v10
    v_mov_b32 v11, s31
    v_mov_b32 v9, s30
    v_cndmask_b32 v11, v9, v11, vcc
    v_add_u32 v6, v6, v11
    s_waitcnt lgkmcnt(0)
    s_mov_b32 s12, s4
    s_and_b32 s13, s5, 0xffff
    s_mov_b32 s14, 0x280000
    s_mov_b32 s15, 0x00020000
    s_mov_b32 s16, s6
    s_and_b32 s17, s7, 0xffff
    s_mov_b32 s18, 0x258000
    s_mov_b32 s19, 0x00020000
    s_mov_b32 s20, s8
    s_and_b32 s21, s9, 0xffff
    s_mov_b32 s22, 0x69a000
    s_mov_b32 s23, 0x00020000
    s_lshl_b32 s30, s25, 7
    s_lshl_b32 s31, s24, 4
    s_add_u32 s30, s30, s31
    s_mul_i32 s27, s30, 1280
    s_mul_i32 s28, s24, 30720
    s_and_b32 s30, s26, -2
    s_mul_i32 s30, s30, 80
    s_add_u32 s28, s28, s30
    s_lshl_b32 s29, s24, 11
    s_add_u32 m0, s29, 0x0
    s_add_u32 s33, s27, 0x0
    buffer_load_dwordx4 v4, s[12:15], s33 offen lds
    s_add_u32 m0, s29, 0x400
    s_add_u32 s33, s27, 0x2800
    buffer_load_dwordx4 v5, s[12:15], s33 offen lds
    s_add_u32 m0, s29, 0x4000
    s_add_u32 s34, s28, 0x0
    buffer_load_dwordx4 v6, s[16:19], s34 offen lds
    s_add_u32 m0, s29, 0x4400
    s_add_u32 s34, s28, 0x3c00
    buffer_load_dwordx4 v6, s[16:19], s34 offen lds
    s_add_u32 m0, s29, 0x8000
    s_add_u32 s33, s27, 0x80
    buffer_load_dwordx4 v4, s[12:15], s33 offen lds
    s_add_u32 m0, s29, 0x8400
    s_add_u32 s33, s27, 0x2880
    buffer_load_dwordx4 v5, s[12:15], s33 offen lds
    s_add_u32 m0, s29, 0xc000
    s_add_u32 s34, s28, 0x3c000
    buffer_load_dwordx4 v6, s[16:19], s34 offen lds
    s_add_u32 m0, s29, 0xc400
    s_add_u32 s34, s28, 0x3fc00
    buffer_load_dwordx4 v6, s[16:19], s34 offen lds
    s_add_u32 m0, s29, 0x10000
    s_add_u32 s33, s27, 0x100
    buffer_load_dwordx4 v4, s[12:15], s33 offen lds
    s_add_u32 m0, s29, 0x10400
    s_add_u32 s33, s27, 0x2900
    buffer_load_dwordx4 v5, s[12:15], s33 offen lds
    s_add_u32 m0, s29, 0x14000
    s_add_u32 s34, s28, 0x78000
    buffer_load_dwordx4 v6, s[16:19], s34 offen lds
    s_add_u32 m0, s29, 0x14400
    s_add_u32 s34, s28, 0x7bc00
    buffer_load_dwordx4 v6, s[16:19], s34 offen lds
    s_add_u32 m0, s29, 0x18000
    s_add_u32 s33, s27, 0x180
    buffer_load_dwordx4 v4, s[12:15], s33 offen lds
    s_add_u32 m0, s29, 0x18400
    s_add_u32 s33, s27, 0x2980
    buffer_load_dwordx4 v5, s[12:15], s33 offen lds
    s_add_u32 m0, s29, 0x1c000
    s_add_u32 s34, s28, 0xb4000
    buffer_load_dwordx4 v6, s[16:19], s34 offen lds
    s_add_u32 m0, s29, 0x1c400
    s_add_u32 s34, s28, 0xb7c00
    buffer_load_dwordx4 v6, s[16:19], s34 offen lds
    v_and_b32 v2, 15, v1
    v_lshrrev_b32 v3, 4, v1
    s_lshl_b32 s32, s24, 4
    v_add_u32 v8, s32, v2
    v_lshlrev_b32 v8, 7, v8
    v_lshrrev_b32 v9, 1, v2
    v_xor_b32 v10, v3, v9
    v_lshl_add_u32 v12, v10, 4, v8
    v_xor_b32 v10, 4, v10
    v_lshl_add_u32 v13, v10, 4, v8
    v_add_u32 v14, 0x10000, v12
    v_add_u32 v15, 0x10000, v13
    v_add_u32 v16, 0x20000, v12
    v_add_u32 v17, 0x20000, v13
    v_lshrrev_b32 v8, 2, v2
    v_lshl_add_u32 v9, v3, 3, v8
    v_lshlrev_b32 v9, 8, v9
    v_add_u32 v9, 16384, v9
    v_and_b32 v10, 1, v1
    v_lshl_add_u32 v9, v10, 3, v9
    v_and_b32 v10, 1, v3
    v_lshlrev_b32 v10, 3, v10
    v_lshl_add_u32 v10, v8, 1, v10
    v_bfe_u32 v11, v1, 1, 1
    v_add_u32 v2, 0, v11
    v_xor_b32 v2, v2, v10
    v_lshl_add_u32 v20, v2, 4, v9
    v_add_u32 v28, 0x10000, v20
    v_add_u32 v36, 0x20000, v20
    v_add_u32 v2, 2, v11
    v_xor_b32 v2, v2, v10
    v_lshl_add_u32 v21, v2, 4, v9
    v_add_u32 v29, 0x10000, v21
    v_add_u32 v37, 0x20000, v21
    v_add_u32 v2, 4, v11
    v_xor_b32 v2, v2, v10
    v_lshl_add_u32 v22, v2, 4, v9
    v_add_u32 v30, 0x10000, v22
    v_add_u32 v38, 0x20000, v22
    v_add_u32 v2, 6, v11
    v_xor_b32 v2, v2, v10
    v_lshl_add_u32 v23, v2, 4, v9
    v_add_u32 v31, 0x10000, v23
    v_add_u32 v39, 0x20000, v23
    v_add_u32 v2, 8, v11
    v_xor_b32 v2, v2, v10
    v_lshl_add_u32 v24, v2, 4, v9
    v_add_u32 v32, 0x10000, v24
    v_add_u32 v40, 0x20000, v24
    v_add_u32 v2, 10, v11
    v_xor_b32 v2, v2, v10
    v_lshl_add_u32 v25, v2, 4, v9
    v_add_u32 v33, 0x10000, v25
    v_add_u32 v41, 0x20000, v25
    v_add_u32 v2, 12, v11
    v_xor_b32 v2, v2, v10
    v_lshl_add_u32 v26, v2, 4, v9
    v_add_u32 v34, 0x10000, v26
    v_add_u32 v42, 0x20000, v26
    v_add_u32 v2, 14, v11
    v_xor_b32 v2, v2, v10
    v_lshl_add_u32 v27, v2, 4, v9
    v_add_u32 v35, 0x10000, v27
    v_add_u32 v43, 0x20000, v27
    v_mov_b32 v48, 0
    v_mov_b32 v49, 0
    v_mov_b32 v50, 0
    v_mov_b32 v51, 0
    v_mov_b32 v52, 0
    v_mov_b32 v53, 0
    v_mov_b32 v54, 0
    v_mov_b32 v55, 0
    v_mov_b32 v56, 0
    v_mov_b32 v57, 0
    v_mov_b32 v58, 0
    v_mov_b32 v59, 0
    v_mov_b32 v60, 0
    v_mov_b32 v61, 0
    v_mov_b32 v62, 0
    v_mov_b32 v63, 0
    v_mov_b32 v64, 0
    v_mov_b32 v65, 0
    v_mov_b32 v66, 0
    v_mov_b32 v67, 0
    v_mov_b32 v68, 0
    v_mov_b32 v69, 0
    v_mov_b32 v70, 0
    v_mov_b32 v71, 0
    v_mov_b32 v72, 0
    v_mov_b32 v73, 0
    v_mov_b32 v74, 0
    v_mov_b32 v75, 0
    v_mov_b32 v76, 0
    v_mov_b32 v77, 0
    v_mov_b32 v78, 0
    v_mov_b32 v79, 0
    s_waitcnt vmcnt(12)
    s_barrier
    ds_read_b128 v[80:83], v12 offset:0
    ds_read_b64_tr_b16 v[84:85], v20 offset:0
    ds_read_b64_tr_b16 v[86:87], v20 offset:1024
    ds_read_b64_tr_b16 v[88:89], v21 offset:0
    ds_read_b64_tr_b16 v[90:91], v21 offset:1024
    ds_read_b64_tr_b16 v[92:93], v22 offset:0
    ds_read_b64_tr_b16 v[94:95], v22 offset:1024
    ds_read_b64_tr_b16 v[96:97], v23 offset:0
    ds_read_b64_tr_b16 v[98:99], v23 offset:1024
    ds_read_b64_tr_b16 v[100:101], v24 offset:0
    ds_read_b64_tr_b16 v[102:103], v24 offset:1024
    ds_read_b64_tr_b16 v[104:105], v25 offset:0
    ds_read_b64_tr_b16 v[106:107], v25 offset:1024
    ds_read_b64_tr_b16 v[108:109], v26 offset:0
    ds_read_b64_tr_b16 v[110:111], v26 offset:1024
    ds_read_b64_tr_b16 v[112:113], v27 offset:0
    ds_read_b64_tr_b16 v[114:115], v27 offset:1024
    s_waitcnt lgkmcnt(0)
    v_mfma_f32_16x16x32_bf16 v[48:51], v[80:83], v[84:87], v[48:51]
    ds_read_b128 v[116:119], v13 offset:0
    ds_read_b64_tr_b16 v[120:121], v20 offset:8192
    ds_read_b64_tr_b16 v[122:123], v20 offset:9216
    v_mfma_f32_16x16x32_bf16 v[52:55], v[80:83], v[88:91], v[52:55]
    ds_read_b64_tr_b16 v[124:125], v21 offset:8192
    ds_read_b64_tr_b16 v[126:127], v21 offset:9216
    ds_read_b64_tr_b16 v[128:129], v22 offset:8192
    v_mfma_f32_16x16x32_bf16 v[56:59], v[80:83], v[92:95], v[56:59]
    ds_read_b64_tr_b16 v[130:131], v22 offset:9216
    ds_read_b64_tr_b16 v[132:133], v23 offset:8192
    ds_read_b64_tr_b16 v[134:135], v23 offset:9216
    v_mfma_f32_16x16x32_bf16 v[60:63], v[80:83], v[96:99], v[60:63]
    ds_read_b64_tr_b16 v[136:137], v24 offset:8192
    ds_read_b64_tr_b16 v[138:139], v24 offset:9216
    ds_read_b64_tr_b16 v[140:141], v25 offset:8192
    v_mfma_f32_16x16x32_bf16 v[64:67], v[80:83], v[100:103], v[64:67]
    ds_read_b64_tr_b16 v[142:143], v25 offset:9216
    ds_read_b64_tr_b16 v[144:145], v26 offset:8192
    ds_read_b64_tr_b16 v[146:147], v26 offset:9216
    v_mfma_f32_16x16x32_bf16 v[68:71], v[80:83], v[104:107], v[68:71]
    ds_read_b64_tr_b16 v[148:149], v27 offset:8192
    ds_read_b64_tr_b16 v[150:151], v27 offset:9216
    v_mfma_f32_16x16x32_bf16 v[72:75], v[80:83], v[108:111], v[72:75]
    v_mfma_f32_16x16x32_bf16 v[76:79], v[80:83], v[112:115], v[76:79]
    s_waitcnt vmcnt(8)
    s_waitcnt lgkmcnt(0)
    s_barrier
    v_mfma_f32_16x16x32_bf16 v[48:51], v[116:119], v[120:123], v[48:51]
    s_add_u32 m0, s29, 0x20000
    s_add_u32 s33, s27, 0x200
    buffer_load_dwordx4 v4, s[12:15], s33 offen lds
    s_add_u32 m0, s29, 0x20400
    s_add_u32 s33, s27, 0x2a00
    buffer_load_dwordx4 v5, s[12:15], s33 offen lds
    s_add_u32 m0, s29, 0x24000
    s_add_u32 s34, s28, 0xf0000
    buffer_load_dwordx4 v6, s[16:19], s34 offen lds
    v_mfma_f32_16x16x32_bf16 v[52:55], v[116:119], v[124:127], v[52:55]
    s_add_u32 m0, s29, 0x24400
    s_add_u32 s34, s28, 0xf3c00
    buffer_load_dwordx4 v6, s[16:19], s34 offen lds
    ds_read_b128 v[80:83], v12 offset:32768
    ds_read_b64_tr_b16 v[84:85], v20 offset:32768
    v_mfma_f32_16x16x32_bf16 v[56:59], v[116:119], v[128:131], v[56:59]
    ds_read_b64_tr_b16 v[86:87], v20 offset:33792
    ds_read_b64_tr_b16 v[88:89], v21 offset:32768
    ds_read_b64_tr_b16 v[90:91], v21 offset:33792
    v_mfma_f32_16x16x32_bf16 v[60:63], v[116:119], v[132:135], v[60:63]
    ds_read_b64_tr_b16 v[92:93], v22 offset:32768
    ds_read_b64_tr_b16 v[94:95], v22 offset:33792
    ds_read_b64_tr_b16 v[96:97], v23 offset:32768
    v_mfma_f32_16x16x32_bf16 v[64:67], v[116:119], v[136:139], v[64:67]
    ds_read_b64_tr_b16 v[98:99], v23 offset:33792
    ds_read_b64_tr_b16 v[100:101], v24 offset:32768
    ds_read_b64_tr_b16 v[102:103], v24 offset:33792
    v_mfma_f32_16x16x32_bf16 v[68:71], v[116:119], v[140:143], v[68:71]
    ds_read_b64_tr_b16 v[104:105], v25 offset:32768
    ds_read_b64_tr_b16 v[106:107], v25 offset:33792
    ds_read_b64_tr_b16 v[108:109], v26 offset:32768
    v_mfma_f32_16x16x32_bf16 v[72:75], v[116:119], v[144:147], v[72:75]
    ds_read_b64_tr_b16 v[110:111], v26 offset:33792
    ds_read_b64_tr_b16 v[112:113], v27 offset:32768
    ds_read_b64_tr_b16 v[114:115], v27 offset:33792
    v_mfma_f32_16x16x32_bf16 v[76:79], v[116:119], v[148:151], v[76:79]
    s_waitcnt lgkmcnt(0)
    v_mfma_f32_16x16x32_bf16 v[48:51], v[80:83], v[84:87], v[48:51]
    ds_read_b128 v[116:119], v13 offset:32768
    ds_read_b64_tr_b16 v[120:121], v20 offset:40960
    ds_read_b64_tr_b16 v[122:123], v20 offset:41984
    v_mfma_f32_16x16x32_bf16 v[52:55], v[80:83], v[88:91], v[52:55]
    ds_read_b64_tr_b16 v[124:125], v21 offset:40960
    ds_read_b64_tr_b16 v[126:127], v21 offset:41984
    ds_read_b64_tr_b16 v[128:129], v22 offset:40960
    v_mfma_f32_16x16x32_bf16 v[56:59], v[80:83], v[92:95], v[56:59]
    ds_read_b64_tr_b16 v[130:131], v22 offset:41984
    ds_read_b64_tr_b16 v[132:133], v23 offset:40960
    ds_read_b64_tr_b16 v[134:135], v23 offset:41984
    v_mfma_f32_16x16x32_bf16 v[60:63], v[80:83], v[96:99], v[60:63]
    ds_read_b64_tr_b16 v[136:137], v24 offset:40960
    ds_read_b64_tr_b16 v[138:139], v24 offset:41984
    ds_read_b64_tr_b16 v[140:141], v25 offset:40960
    v_mfma_f32_16x16x32_bf16 v[64:67], v[80:83], v[100:103], v[64:67]
    ds_read_b64_tr_b16 v[142:143], v25 offset:41984
    ds_read_b64_tr_b16 v[144:145], v26 offset:40960
    ds_read_b64_tr_b16 v[146:147], v26 offset:41984
    v_mfma_f32_16x16x32_bf16 v[68:71], v[80:83], v[104:107], v[68:71]
    ds_read_b64_tr_b16 v[148:149], v27 offset:40960
    ds_read_b64_tr_b16 v[150:151], v27 offset:41984
    v_mfma_f32_16x16x32_bf16 v[72:75], v[80:83], v[108:111], v[72:75]
    v_mfma_f32_16x16x32_bf16 v[76:79], v[80:83], v[112:115], v[76:79]
    s_waitcnt vmcnt(8)
    s_waitcnt lgkmcnt(0)
    s_barrier
    v_mfma_f32_16x16x32_bf16 v[48:51], v[116:119], v[120:123], v[48:51]
    s_add_u32 m0, s29, 0x0
    s_add_u32 s33, s27, 0x280
    buffer_load_dwordx4 v4, s[12:15], s33 offen lds
    s_add_u32 m0, s29, 0x400
    s_add_u32 s33, s27, 0x2a80
    buffer_load_dwordx4 v5, s[12:15], s33 offen lds
    s_add_u32 m0, s29, 0x4000
    s_add_u32 s34, s28, 0x12c000
    buffer_load_dwordx4 v6, s[16:19], s34 offen lds
    v_mfma_f32_16x16x32_bf16 v[52:55], v[116:119], v[124:127], v[52:55]
    s_add_u32 m0, s29, 0x4400
    s_add_u32 s34, s28, 0x12fc00
    buffer_load_dwordx4 v6, s[16:19], s34 offen lds
    ds_read_b128 v[80:83], v14 offset:0
    ds_read_b64_tr_b16 v[84:85], v28 offset:0
    v_mfma_f32_16x16x32_bf16 v[56:59], v[116:119], v[128:131], v[56:59]
    ds_read_b64_tr_b16 v[86:87], v28 offset:1024
    ds_read_b64_tr_b16 v[88:89], v29 offset:0
    ds_read_b64_tr_b16 v[90:91], v29 offset:1024
    v_mfma_f32_16x16x32_bf16 v[60:63], v[116:119], v[132:135], v[60:63]
    ds_read_b64_tr_b16 v[92:93], v30 offset:0
    ds_read_b64_tr_b16 v[94:95], v30 offset:1024
    ds_read_b64_tr_b16 v[96:97], v31 offset:0
    v_mfma_f32_16x16x32_bf16 v[64:67], v[116:119], v[136:139], v[64:67]
    ds_read_b64_tr_b16 v[98:99], v31 offset:1024
    ds_read_b64_tr_b16 v[100:101], v32 offset:0
    ds_read_b64_tr_b16 v[102:103], v32 offset:1024
    v_mfma_f32_16x16x32_bf16 v[68:71], v[116:119], v[140:143], v[68:71]
    ds_read_b64_tr_b16 v[104:105], v33 offset:0
    ds_read_b64_tr_b16 v[106:107], v33 offset:1024
    ds_read_b64_tr_b16 v[108:109], v34 offset:0
    v_mfma_f32_16x16x32_bf16 v[72:75], v[116:119], v[144:147], v[72:75]
    ds_read_b64_tr_b16 v[110:111], v34 offset:1024
    ds_read_b64_tr_b16 v[112:113], v35 offset:0
    ds_read_b64_tr_b16 v[114:115], v35 offset:1024
    v_mfma_f32_16x16x32_bf16 v[76:79], v[116:119], v[148:151], v[76:79]
    s_waitcnt lgkmcnt(0)
    v_mfma_f32_16x16x32_bf16 v[48:51], v[80:83], v[84:87], v[48:51]
    ds_read_b128 v[116:119], v15 offset:0
    ds_read_b64_tr_b16 v[120:121], v28 offset:8192
    ds_read_b64_tr_b16 v[122:123], v28 offset:9216
    v_mfma_f32_16x16x32_bf16 v[52:55], v[80:83], v[88:91], v[52:55]
    ds_read_b64_tr_b16 v[124:125], v29 offset:8192
    ds_read_b64_tr_b16 v[126:127], v29 offset:9216
    ds_read_b64_tr_b16 v[128:129], v30 offset:8192
    v_mfma_f32_16x16x32_bf16 v[56:59], v[80:83], v[92:95], v[56:59]
    ds_read_b64_tr_b16 v[130:131], v30 offset:9216
    ds_read_b64_tr_b16 v[132:133], v31 offset:8192
    ds_read_b64_tr_b16 v[134:135], v31 offset:9216
    v_mfma_f32_16x16x32_bf16 v[60:63], v[80:83], v[96:99], v[60:63]
    ds_read_b64_tr_b16 v[136:137], v32 offset:8192
    ds_read_b64_tr_b16 v[138:139], v32 offset:9216
    ds_read_b64_tr_b16 v[140:141], v33 offset:8192
    v_mfma_f32_16x16x32_bf16 v[64:67], v[80:83], v[100:103], v[64:67]
    ds_read_b64_tr_b16 v[142:143], v33 offset:9216
    ds_read_b64_tr_b16 v[144:145], v34 offset:8192
    ds_read_b64_tr_b16 v[146:147], v34 offset:9216
    v_mfma_f32_16x16x32_bf16 v[68:71], v[80:83], v[104:107], v[68:71]
    ds_read_b64_tr_b16 v[148:149], v35 offset:8192
    ds_read_b64_tr_b16 v[150:151], v35 offset:9216
    v_mfma_f32_16x16x32_bf16 v[72:75], v[80:83], v[108:111], v[72:75]
    v_mfma_f32_16x16x32_bf16 v[76:79], v[80:83], v[112:115], v[76:79]
    s_waitcnt vmcnt(8)
    s_waitcnt lgkmcnt(0)
    s_barrier
    v_mfma_f32_16x16x32_bf16 v[48:51], v[116:119], v[120:123], v[48:51]
    s_add_u32 m0, s29, 0x8000
    s_add_u32 s33, s27, 0x300
    buffer_load_dwordx4 v4, s[12:15], s33 offen lds
    s_add_u32 m0, s29, 0x8400
    s_add_u32 s33, s27, 0x2b00
    buffer_load_dwordx4 v5, s[12:15], s33 offen lds
    s_add_u32 m0, s29, 0xc000
    s_add_u32 s34, s28, 0x168000
    buffer_load_dwordx4 v6, s[16:19], s34 offen lds
    v_mfma_f32_16x16x32_bf16 v[52:55], v[116:119], v[124:127], v[52:55]
    s_add_u32 m0, s29, 0xc400
    s_add_u32 s34, s28, 0x16bc00
    buffer_load_dwordx4 v6, s[16:19], s34 offen lds
    ds_read_b128 v[80:83], v14 offset:32768
    ds_read_b64_tr_b16 v[84:85], v28 offset:32768
    v_mfma_f32_16x16x32_bf16 v[56:59], v[116:119], v[128:131], v[56:59]
    ds_read_b64_tr_b16 v[86:87], v28 offset:33792
    ds_read_b64_tr_b16 v[88:89], v29 offset:32768
    ds_read_b64_tr_b16 v[90:91], v29 offset:33792
    v_mfma_f32_16x16x32_bf16 v[60:63], v[116:119], v[132:135], v[60:63]
    ds_read_b64_tr_b16 v[92:93], v30 offset:32768
    ds_read_b64_tr_b16 v[94:95], v30 offset:33792
    ds_read_b64_tr_b16 v[96:97], v31 offset:32768
    v_mfma_f32_16x16x32_bf16 v[64:67], v[116:119], v[136:139], v[64:67]
    ds_read_b64_tr_b16 v[98:99], v31 offset:33792
    ds_read_b64_tr_b16 v[100:101], v32 offset:32768
    ds_read_b64_tr_b16 v[102:103], v32 offset:33792
    v_mfma_f32_16x16x32_bf16 v[68:71], v[116:119], v[140:143], v[68:71]
    ds_read_b64_tr_b16 v[104:105], v33 offset:32768
    ds_read_b64_tr_b16 v[106:107], v33 offset:33792
    ds_read_b64_tr_b16 v[108:109], v34 offset:32768
    v_mfma_f32_16x16x32_bf16 v[72:75], v[116:119], v[144:147], v[72:75]
    ds_read_b64_tr_b16 v[110:111], v34 offset:33792
    ds_read_b64_tr_b16 v[112:113], v35 offset:32768
    ds_read_b64_tr_b16 v[114:115], v35 offset:33792
    v_mfma_f32_16x16x32_bf16 v[76:79], v[116:119], v[148:151], v[76:79]
    s_waitcnt lgkmcnt(0)
    v_mfma_f32_16x16x32_bf16 v[48:51], v[80:83], v[84:87], v[48:51]
    ds_read_b128 v[116:119], v15 offset:32768
    ds_read_b64_tr_b16 v[120:121], v28 offset:40960
    ds_read_b64_tr_b16 v[122:123], v28 offset:41984
    v_mfma_f32_16x16x32_bf16 v[52:55], v[80:83], v[88:91], v[52:55]
    ds_read_b64_tr_b16 v[124:125], v29 offset:40960
    ds_read_b64_tr_b16 v[126:127], v29 offset:41984
    ds_read_b64_tr_b16 v[128:129], v30 offset:40960
    v_mfma_f32_16x16x32_bf16 v[56:59], v[80:83], v[92:95], v[56:59]
    ds_read_b64_tr_b16 v[130:131], v30 offset:41984
    ds_read_b64_tr_b16 v[132:133], v31 offset:40960
    ds_read_b64_tr_b16 v[134:135], v31 offset:41984
    v_mfma_f32_16x16x32_bf16 v[60:63], v[80:83], v[96:99], v[60:63]
    ds_read_b64_tr_b16 v[136:137], v32 offset:40960
    ds_read_b64_tr_b16 v[138:139], v32 offset:41984
    ds_read_b64_tr_b16 v[140:141], v33 offset:40960
    v_mfma_f32_16x16x32_bf16 v[64:67], v[80:83], v[100:103], v[64:67]
    ds_read_b64_tr_b16 v[142:143], v33 offset:41984
    ds_read_b64_tr_b16 v[144:145], v34 offset:40960
    ds_read_b64_tr_b16 v[146:147], v34 offset:41984
    v_mfma_f32_16x16x32_bf16 v[68:71], v[80:83], v[104:107], v[68:71]
    ds_read_b64_tr_b16 v[148:149], v35 offset:40960
    ds_read_b64_tr_b16 v[150:151], v35 offset:41984
    v_mfma_f32_16x16x32_bf16 v[72:75], v[80:83], v[108:111], v[72:75]
    v_mfma_f32_16x16x32_bf16 v[76:79], v[80:83], v[112:115], v[76:79]
    s_waitcnt vmcnt(8)
    s_waitcnt lgkmcnt(0)
    s_barrier
    v_mfma_f32_16x16x32_bf16 v[48:51], v[116:119], v[120:123], v[48:51]
    s_add_u32 m0, s29, 0x10000
    s_add_u32 s33, s27, 0x380
    buffer_load_dwordx4 v4, s[12:15], s33 offen lds
    s_add_u32 m0, s29, 0x10400
    s_add_u32 s33, s27, 0x2b80
    buffer_load_dwordx4 v5, s[12:15], s33 offen lds
    s_add_u32 m0, s29, 0x14000
    s_add_u32 s34, s28, 0x1a4000
    buffer_load_dwordx4 v6, s[16:19], s34 offen lds
    v_mfma_f32_16x16x32_bf16 v[52:55], v[116:119], v[124:127], v[52:55]
    s_add_u32 m0, s29, 0x14400
    s_add_u32 s34, s28, 0x1a7c00
    buffer_load_dwordx4 v6, s[16:19], s34 offen lds
    ds_read_b128 v[80:83], v16 offset:0
    ds_read_b64_tr_b16 v[84:85], v36 offset:0
    v_mfma_f32_16x16x32_bf16 v[56:59], v[116:119], v[128:131], v[56:59]
    ds_read_b64_tr_b16 v[86:87], v36 offset:1024
    ds_read_b64_tr_b16 v[88:89], v37 offset:0
    ds_read_b64_tr_b16 v[90:91], v37 offset:1024
    v_mfma_f32_16x16x32_bf16 v[60:63], v[116:119], v[132:135], v[60:63]
    ds_read_b64_tr_b16 v[92:93], v38 offset:0
    ds_read_b64_tr_b16 v[94:95], v38 offset:1024
    ds_read_b64_tr_b16 v[96:97], v39 offset:0
    v_mfma_f32_16x16x32_bf16 v[64:67], v[116:119], v[136:139], v[64:67]
    ds_read_b64_tr_b16 v[98:99], v39 offset:1024
    ds_read_b64_tr_b16 v[100:101], v40 offset:0
    ds_read_b64_tr_b16 v[102:103], v40 offset:1024
    v_mfma_f32_16x16x32_bf16 v[68:71], v[116:119], v[140:143], v[68:71]
    ds_read_b64_tr_b16 v[104:105], v41 offset:0
    ds_read_b64_tr_b16 v[106:107], v41 offset:1024
    ds_read_b64_tr_b16 v[108:109], v42 offset:0
    v_mfma_f32_16x16x32_bf16 v[72:75], v[116:119], v[144:147], v[72:75]
    ds_read_b64_tr_b16 v[110:111], v42 offset:1024
    ds_read_b64_tr_b16 v[112:113], v43 offset:0
    ds_read_b64_tr_b16 v[114:115], v43 offset:1024
    v_mfma_f32_16x16x32_bf16 v[76:79], v[116:119], v[148:151], v[76:79]
    s_waitcnt lgkmcnt(0)
    v_mfma_f32_16x16x32_bf16 v[48:51], v[80:83], v[84:87], v[48:51]
    ds_read_b128 v[116:119], v17 offset:0
    ds_read_b64_tr_b16 v[120:121], v36 offset:8192
    ds_read_b64_tr_b16 v[122:123], v36 offset:9216
    v_mfma_f32_16x16x32_bf16 v[52:55], v[80:83], v[88:91], v[52:55]
    ds_read_b64_tr_b16 v[124:125], v37 offset:8192
    ds_read_b64_tr_b16 v[126:127], v37 offset:9216
    ds_read_b64_tr_b16 v[128:129], v38 offset:8192
    v_mfma_f32_16x16x32_bf16 v[56:59], v[80:83], v[92:95], v[56:59]
    ds_read_b64_tr_b16 v[130:131], v38 offset:9216
    ds_read_b64_tr_b16 v[132:133], v39 offset:8192
    ds_read_b64_tr_b16 v[134:135], v39 offset:9216
    v_mfma_f32_16x16x32_bf16 v[60:63], v[80:83], v[96:99], v[60:63]
    ds_read_b64_tr_b16 v[136:137], v40 offset:8192
    ds_read_b64_tr_b16 v[138:139], v40 offset:9216
    ds_read_b64_tr_b16 v[140:141], v41 offset:8192
    v_mfma_f32_16x16x32_bf16 v[64:67], v[80:83], v[100:103], v[64:67]
    ds_read_b64_tr_b16 v[142:143], v41 offset:9216
    ds_read_b64_tr_b16 v[144:145], v42 offset:8192
    ds_read_b64_tr_b16 v[146:147], v42 offset:9216
    v_mfma_f32_16x16x32_bf16 v[68:71], v[80:83], v[104:107], v[68:71]
    ds_read_b64_tr_b16 v[148:149], v43 offset:8192
    ds_read_b64_tr_b16 v[150:151], v43 offset:9216
    v_mfma_f32_16x16x32_bf16 v[72:75], v[80:83], v[108:111], v[72:75]
    v_mfma_f32_16x16x32_bf16 v[76:79], v[80:83], v[112:115], v[76:79]
    s_waitcnt vmcnt(8)
    s_waitcnt lgkmcnt(0)
    s_barrier
    v_mfma_f32_16x16x32_bf16 v[48:51], v[116:119], v[120:123], v[48:51]
    s_add_u32 m0, s29, 0x18000
    s_add_u32 s33, s27, 0x400
    buffer_load_dwordx4 v4, s[12:15], s33 offen lds
    s_add_u32 m0, s29, 0x18400
    s_add_u32 s33, s27, 0x2c00
    buffer_load_dwordx4 v5, s[12:15], s33 offen lds
    s_add_u32 m0, s29, 0x1c000
    s_add_u32 s34, s28, 0x1e0000
    buffer_load_dwordx4 v6, s[16:19], s34 offen lds
    v_mfma_f32_16x16x32_bf16 v[52:55], v[116:119], v[124:127], v[52:55]
    s_add_u32 m0, s29, 0x1c400
    s_add_u32 s34, s28, 0x1e3c00
    buffer_load_dwordx4 v6, s[16:19], s34 offen lds
    ds_read_b128 v[80:83], v12 offset:0
    ds_read_b64_tr_b16 v[84:85], v20 offset:0
    v_mfma_f32_16x16x32_bf16 v[56:59], v[116:119], v[128:131], v[56:59]
    ds_read_b64_tr_b16 v[86:87], v20 offset:1024
    ds_read_b64_tr_b16 v[88:89], v21 offset:0
    ds_read_b64_tr_b16 v[90:91], v21 offset:1024
    v_mfma_f32_16x16x32_bf16 v[60:63], v[116:119], v[132:135], v[60:63]
    ds_read_b64_tr_b16 v[92:93], v22 offset:0
    ds_read_b64_tr_b16 v[94:95], v22 offset:1024
    ds_read_b64_tr_b16 v[96:97], v23 offset:0
    v_mfma_f32_16x16x32_bf16 v[64:67], v[116:119], v[136:139], v[64:67]
    ds_read_b64_tr_b16 v[98:99], v23 offset:1024
    ds_read_b64_tr_b16 v[100:101], v24 offset:0
    ds_read_b64_tr_b16 v[102:103], v24 offset:1024
    v_mfma_f32_16x16x32_bf16 v[68:71], v[116:119], v[140:143], v[68:71]
    ds_read_b64_tr_b16 v[104:105], v25 offset:0
    ds_read_b64_tr_b16 v[106:107], v25 offset:1024
    ds_read_b64_tr_b16 v[108:109], v26 offset:0
    v_mfma_f32_16x16x32_bf16 v[72:75], v[116:119], v[144:147], v[72:75]
    ds_read_b64_tr_b16 v[110:111], v26 offset:1024
    ds_read_b64_tr_b16 v[112:113], v27 offset:0
    ds_read_b64_tr_b16 v[114:115], v27 offset:1024
    v_mfma_f32_16x16x32_bf16 v[76:79], v[116:119], v[148:151], v[76:79]
    s_waitcnt lgkmcnt(0)
    v_mfma_f32_16x16x32_bf16 v[48:51], v[80:83], v[84:87], v[48:51]
    ds_read_b128 v[116:119], v13 offset:0
    ds_read_b64_tr_b16 v[120:121], v20 offset:8192
    ds_read_b64_tr_b16 v[122:123], v20 offset:9216
    v_mfma_f32_16x16x32_bf16 v[52:55], v[80:83], v[88:91], v[52:55]
    ds_read_b64_tr_b16 v[124:125], v21 offset:8192
    ds_read_b64_tr_b16 v[126:127], v21 offset:9216
    ds_read_b64_tr_b16 v[128:129], v22 offset:8192
    v_mfma_f32_16x16x32_bf16 v[56:59], v[80:83], v[92:95], v[56:59]
    ds_read_b64_tr_b16 v[130:131], v22 offset:9216
    ds_read_b64_tr_b16 v[132:133], v23 offset:8192
    ds_read_b64_tr_b16 v[134:135], v23 offset:9216
    v_mfma_f32_16x16x32_bf16 v[60:63], v[80:83], v[96:99], v[60:63]
    ds_read_b64_tr_b16 v[136:137], v24 offset:8192
    ds_read_b64_tr_b16 v[138:139], v24 offset:9216
    ds_read_b64_tr_b16 v[140:141], v25 offset:8192
    v_mfma_f32_16x16x32_bf16 v[64:67], v[80:83], v[100:103], v[64:67]
    ds_read_b64_tr_b16 v[142:143], v25 offset:9216
    ds_read_b64_tr_b16 v[144:145], v26 offset:8192
    ds_read_b64_tr_b16 v[146:147], v26 offset:9216
    v_mfma_f32_16x16x32_bf16 v[68:71], v[80:83], v[104:107], v[68:71]
    ds_read_b64_tr_b16 v[148:149], v27 offset:8192
    ds_read_b64_tr_b16 v[150:151], v27 offset:9216
    v_mfma_f32_16x16x32_bf16 v[72:75], v[80:83], v[108:111], v[72:75]
    v_mfma_f32_16x16x32_bf16 v[76:79], v[80:83], v[112:115], v[76:79]
    s_waitcnt vmcnt(8)
    s_waitcnt lgkmcnt(0)
    s_barrier
    v_mfma_f32_16x16x32_bf16 v[48:51], v[116:119], v[120:123], v[48:51]
    s_add_u32 m0, s29, 0x20000
    s_add_u32 s33, s27, 0x480
    buffer_load_dwordx4 v4, s[12:15], s33 offen lds
    s_add_u32 m0, s29, 0x20400
    s_add_u32 s33, s27, 0x2c80
    buffer_load_dwordx4 v5, s[12:15], s33 offen lds
    s_add_u32 m0, s29, 0x24000
    s_add_u32 s34, s28, 0x21c000
    buffer_load_dwordx4 v6, s[16:19], s34 offen lds
    v_mfma_f32_16x16x32_bf16 v[52:55], v[116:119], v[124:127], v[52:55]
    s_add_u32 m0, s29, 0x24400
    s_add_u32 s34, s28, 0x21fc00
    buffer_load_dwordx4 v6, s[16:19], s34 offen lds
    ds_read_b128 v[80:83], v12 offset:32768
    ds_read_b64_tr_b16 v[84:85], v20 offset:32768
    v_mfma_f32_16x16x32_bf16 v[56:59], v[116:119], v[128:131], v[56:59]
    ds_read_b64_tr_b16 v[86:87], v20 offset:33792
    ds_read_b64_tr_b16 v[88:89], v21 offset:32768
    ds_read_b64_tr_b16 v[90:91], v21 offset:33792
    v_mfma_f32_16x16x32_bf16 v[60:63], v[116:119], v[132:135], v[60:63]
    ds_read_b64_tr_b16 v[92:93], v22 offset:32768
    ds_read_b64_tr_b16 v[94:95], v22 offset:33792
    ds_read_b64_tr_b16 v[96:97], v23 offset:32768
    v_mfma_f32_16x16x32_bf16 v[64:67], v[116:119], v[136:139], v[64:67]
    ds_read_b64_tr_b16 v[98:99], v23 offset:33792
    ds_read_b64_tr_b16 v[100:101], v24 offset:32768
    ds_read_b64_tr_b16 v[102:103], v24 offset:33792
    v_mfma_f32_16x16x32_bf16 v[68:71], v[116:119], v[140:143], v[68:71]
    ds_read_b64_tr_b16 v[104:105], v25 offset:32768
    ds_read_b64_tr_b16 v[106:107], v25 offset:33792
    ds_read_b64_tr_b16 v[108:109], v26 offset:32768
    v_mfma_f32_16x16x32_bf16 v[72:75], v[116:119], v[144:147], v[72:75]
    ds_read_b64_tr_b16 v[110:111], v26 offset:33792
    ds_read_b64_tr_b16 v[112:113], v27 offset:32768
    ds_read_b64_tr_b16 v[114:115], v27 offset:33792
    v_mfma_f32_16x16x32_bf16 v[76:79], v[116:119], v[148:151], v[76:79]
    s_waitcnt lgkmcnt(0)
    v_mfma_f32_16x16x32_bf16 v[48:51], v[80:83], v[84:87], v[48:51]
    ds_read_b128 v[116:119], v13 offset:32768
    ds_read_b64_tr_b16 v[120:121], v20 offset:40960
    ds_read_b64_tr_b16 v[122:123], v20 offset:41984
    v_mfma_f32_16x16x32_bf16 v[52:55], v[80:83], v[88:91], v[52:55]
    ds_read_b64_tr_b16 v[124:125], v21 offset:40960
    ds_read_b64_tr_b16 v[126:127], v21 offset:41984
    ds_read_b64_tr_b16 v[128:129], v22 offset:40960
    v_mfma_f32_16x16x32_bf16 v[56:59], v[80:83], v[92:95], v[56:59]
    ds_read_b64_tr_b16 v[130:131], v22 offset:41984
    ds_read_b64_tr_b16 v[132:133], v23 offset:40960
    ds_read_b64_tr_b16 v[134:135], v23 offset:41984
    v_mfma_f32_16x16x32_bf16 v[60:63], v[80:83], v[96:99], v[60:63]
    ds_read_b64_tr_b16 v[136:137], v24 offset:40960
    ds_read_b64_tr_b16 v[138:139], v24 offset:41984
    ds_read_b64_tr_b16 v[140:141], v25 offset:40960
    v_mfma_f32_16x16x32_bf16 v[64:67], v[80:83], v[100:103], v[64:67]
    ds_read_b64_tr_b16 v[142:143], v25 offset:41984
    ds_read_b64_tr_b16 v[144:145], v26 offset:40960
    ds_read_b64_tr_b16 v[146:147], v26 offset:41984
    v_mfma_f32_16x16x32_bf16 v[68:71], v[80:83], v[104:107], v[68:71]
    ds_read_b64_tr_b16 v[148:149], v27 offset:40960
    ds_read_b64_tr_b16 v[150:151], v27 offset:41984
    v_mfma_f32_16x16x32_bf16 v[72:75], v[80:83], v[108:111], v[72:75]
    v_mfma_f32_16x16x32_bf16 v[76:79], v[80:83], v[112:115], v[76:79]
    s_waitcnt vmcnt(8)
    s_waitcnt lgkmcnt(0)
    s_barrier
    v_mfma_f32_16x16x32_bf16 v[48:51], v[116:119], v[120:123], v[48:51]
    ds_read_b128 v[80:83], v14 offset:0
    ds_read_b64_tr_b16 v[84:85], v28 offset:0
    ds_read_b64_tr_b16 v[86:87], v28 offset:1024
    v_mfma_f32_16x16x32_bf16 v[52:55], v[116:119], v[124:127], v[52:55]
    ds_read_b64_tr_b16 v[88:89], v29 offset:0
    ds_read_b64_tr_b16 v[90:91], v29 offset:1024
    ds_read_b64_tr_b16 v[92:93], v30 offset:0
    v_mfma_f32_16x16x32_bf16 v[56:59], v[116:119], v[128:131], v[56:59]
    ds_read_b64_tr_b16 v[94:95], v30 offset:1024
    ds_read_b64_tr_b16 v[96:97], v31 offset:0
    ds_read_b64_tr_b16 v[98:99], v31 offset:1024
    v_mfma_f32_16x16x32_bf16 v[60:63], v[116:119], v[132:135], v[60:63]
    ds_read_b64_tr_b16 v[100:101], v32 offset:0
    ds_read_b64_tr_b16 v[102:103], v32 offset:1024
    ds_read_b64_tr_b16 v[104:105], v33 offset:0
    v_mfma_f32_16x16x32_bf16 v[64:67], v[116:119], v[136:139], v[64:67]
    ds_read_b64_tr_b16 v[106:107], v33 offset:1024
    ds_read_b64_tr_b16 v[108:109], v34 offset:0
    ds_read_b64_tr_b16 v[110:111], v34 offset:1024
    v_mfma_f32_16x16x32_bf16 v[68:71], v[116:119], v[140:143], v[68:71]
    ds_read_b64_tr_b16 v[112:113], v35 offset:0
    ds_read_b64_tr_b16 v[114:115], v35 offset:1024
    v_mfma_f32_16x16x32_bf16 v[72:75], v[116:119], v[144:147], v[72:75]
    v_mfma_f32_16x16x32_bf16 v[76:79], v[116:119], v[148:151], v[76:79]
    s_waitcnt lgkmcnt(0)
    v_mfma_f32_16x16x32_bf16 v[48:51], v[80:83], v[84:87], v[48:51]
    ds_read_b128 v[116:119], v15 offset:0
    ds_read_b64_tr_b16 v[120:121], v28 offset:8192
    ds_read_b64_tr_b16 v[122:123], v28 offset:9216
    v_mfma_f32_16x16x32_bf16 v[52:55], v[80:83], v[88:91], v[52:55]
    ds_read_b64_tr_b16 v[124:125], v29 offset:8192
    ds_read_b64_tr_b16 v[126:127], v29 offset:9216
    ds_read_b64_tr_b16 v[128:129], v30 offset:8192
    v_mfma_f32_16x16x32_bf16 v[56:59], v[80:83], v[92:95], v[56:59]
    ds_read_b64_tr_b16 v[130:131], v30 offset:9216
    ds_read_b64_tr_b16 v[132:133], v31 offset:8192
    ds_read_b64_tr_b16 v[134:135], v31 offset:9216
    v_mfma_f32_16x16x32_bf16 v[60:63], v[80:83], v[96:99], v[60:63]
    ds_read_b64_tr_b16 v[136:137], v32 offset:8192
    ds_read_b64_tr_b16 v[138:139], v32 offset:9216
    ds_read_b64_tr_b16 v[140:141], v33 offset:8192
    v_mfma_f32_16x16x32_bf16 v[64:67], v[80:83], v[100:103], v[64:67]
    ds_read_b64_tr_b16 v[142:143], v33 offset:9216
    ds_read_b64_tr_b16 v[144:145], v34 offset:8192
    ds_read_b64_tr_b16 v[146:147], v34 offset:9216
    v_mfma_f32_16x16x32_bf16 v[68:71], v[80:83], v[104:107], v[68:71]
    ds_read_b64_tr_b16 v[148:149], v35 offset:8192
    ds_read_b64_tr_b16 v[150:151], v35 offset:9216
    v_mfma_f32_16x16x32_bf16 v[72:75], v[80:83], v[108:111], v[72:75]
    v_mfma_f32_16x16x32_bf16 v[76:79], v[80:83], v[112:115], v[76:79]
    s_waitcnt vmcnt(4)
    s_waitcnt lgkmcnt(0)
    s_barrier
    v_mfma_f32_16x16x32_bf16 v[48:51], v[116:119], v[120:123], v[48:51]
    ds_read_b128 v[80:83], v14 offset:32768
    ds_read_b64_tr_b16 v[84:85], v28 offset:32768
    ds_read_b64_tr_b16 v[86:87], v28 offset:33792
    v_mfma_f32_16x16x32_bf16 v[52:55], v[116:119], v[124:127], v[52:55]
    ds_read_b64_tr_b16 v[88:89], v29 offset:32768
    ds_read_b64_tr_b16 v[90:91], v29 offset:33792
    ds_read_b64_tr_b16 v[92:93], v30 offset:32768
    v_mfma_f32_16x16x32_bf16 v[56:59], v[116:119], v[128:131], v[56:59]
    ds_read_b64_tr_b16 v[94:95], v30 offset:33792
    ds_read_b64_tr_b16 v[96:97], v31 offset:32768
    ds_read_b64_tr_b16 v[98:99], v31 offset:33792
    v_mfma_f32_16x16x32_bf16 v[60:63], v[116:119], v[132:135], v[60:63]
    ds_read_b64_tr_b16 v[100:101], v32 offset:32768
    ds_read_b64_tr_b16 v[102:103], v32 offset:33792
    ds_read_b64_tr_b16 v[104:105], v33 offset:32768
    v_mfma_f32_16x16x32_bf16 v[64:67], v[116:119], v[136:139], v[64:67]
    ds_read_b64_tr_b16 v[106:107], v33 offset:33792
    ds_read_b64_tr_b16 v[108:109], v34 offset:32768
    ds_read_b64_tr_b16 v[110:111], v34 offset:33792
    v_mfma_f32_16x16x32_bf16 v[68:71], v[116:119], v[140:143], v[68:71]
    ds_read_b64_tr_b16 v[112:113], v35 offset:32768
    ds_read_b64_tr_b16 v[114:115], v35 offset:33792
    v_mfma_f32_16x16x32_bf16 v[72:75], v[116:119], v[144:147], v[72:75]
    v_mfma_f32_16x16x32_bf16 v[76:79], v[116:119], v[148:151], v[76:79]
    s_waitcnt lgkmcnt(0)
    v_mfma_f32_16x16x32_bf16 v[48:51], v[80:83], v[84:87], v[48:51]
    ds_read_b128 v[116:119], v15 offset:32768
    ds_read_b64_tr_b16 v[120:121], v28 offset:40960
    ds_read_b64_tr_b16 v[122:123], v28 offset:41984
    v_mfma_f32_16x16x32_bf16 v[52:55], v[80:83], v[88:91], v[52:55]
    ds_read_b64_tr_b16 v[124:125], v29 offset:40960
    ds_read_b64_tr_b16 v[126:127], v29 offset:41984
    ds_read_b64_tr_b16 v[128:129], v30 offset:40960
    v_mfma_f32_16x16x32_bf16 v[56:59], v[80:83], v[92:95], v[56:59]
    ds_read_b64_tr_b16 v[130:131], v30 offset:41984
    ds_read_b64_tr_b16 v[132:133], v31 offset:40960
    ds_read_b64_tr_b16 v[134:135], v31 offset:41984
    v_mfma_f32_16x16x32_bf16 v[60:63], v[80:83], v[96:99], v[60:63]
    ds_read_b64_tr_b16 v[136:137], v32 offset:40960
    ds_read_b64_tr_b16 v[138:139], v32 offset:41984
    ds_read_b64_tr_b16 v[140:141], v33 offset:40960
    v_mfma_f32_16x16x32_bf16 v[64:67], v[80:83], v[100:103], v[64:67]
    ds_read_b64_tr_b16 v[142:143], v33 offset:41984
    ds_read_b64_tr_b16 v[144:145], v34 offset:40960
    ds_read_b64_tr_b16 v[146:147], v34 offset:41984
    v_mfma_f32_16x16x32_bf16 v[68:71], v[80:83], v[104:107], v[68:71]
    ds_read_b64_tr_b16 v[148:149], v35 offset:40960
    ds_read_b64_tr_b16 v[150:151], v35 offset:41984
    v_mfma_f32_16x16x32_bf16 v[72:75], v[80:83], v[108:111], v[72:75]
    v_mfma_f32_16x16x32_bf16 v[76:79], v[80:83], v[112:115], v[76:79]
    s_waitcnt vmcnt(0)
    s_waitcnt lgkmcnt(0)
    s_barrier
    v_mfma_f32_16x16x32_bf16 v[48:51], v[116:119], v[120:123], v[48:51]
    ds_read_b128 v[80:83], v16 offset:0
    ds_read_b64_tr_b16 v[84:85], v36 offset:0
    ds_read_b64_tr_b16 v[86:87], v36 offset:1024
    v_mfma_f32_16x16x32_bf16 v[52:55], v[116:119], v[124:127], v[52:55]
    ds_read_b64_tr_b16 v[88:89], v37 offset:0
    ds_read_b64_tr_b16 v[90:91], v37 offset:1024
    ds_read_b64_tr_b16 v[92:93], v38 offset:0
    v_mfma_f32_16x16x32_bf16 v[56:59], v[116:119], v[128:131], v[56:59]
    ds_read_b64_tr_b16 v[94:95], v38 offset:1024
    ds_read_b64_tr_b16 v[96:97], v39 offset:0
    ds_read_b64_tr_b16 v[98:99], v39 offset:1024
    v_mfma_f32_16x16x32_bf16 v[60:63], v[116:119], v[132:135], v[60:63]
    ds_read_b64_tr_b16 v[100:101], v40 offset:0
    ds_read_b64_tr_b16 v[102:103], v40 offset:1024
    ds_read_b64_tr_b16 v[104:105], v41 offset:0
    v_mfma_f32_16x16x32_bf16 v[64:67], v[116:119], v[136:139], v[64:67]
    ds_read_b64_tr_b16 v[106:107], v41 offset:1024
    ds_read_b64_tr_b16 v[108:109], v42 offset:0
    ds_read_b64_tr_b16 v[110:111], v42 offset:1024
    v_mfma_f32_16x16x32_bf16 v[68:71], v[116:119], v[140:143], v[68:71]
    ds_read_b64_tr_b16 v[112:113], v43 offset:0
    ds_read_b64_tr_b16 v[114:115], v43 offset:1024
    v_mfma_f32_16x16x32_bf16 v[72:75], v[116:119], v[144:147], v[72:75]
    v_mfma_f32_16x16x32_bf16 v[76:79], v[116:119], v[148:151], v[76:79]
    s_waitcnt lgkmcnt(0)
    v_mfma_f32_16x16x32_bf16 v[48:51], v[80:83], v[84:87], v[48:51]
    ds_read_b128 v[116:119], v17 offset:0
    ds_read_b64_tr_b16 v[120:121], v36 offset:8192
    ds_read_b64_tr_b16 v[122:123], v36 offset:9216
    v_mfma_f32_16x16x32_bf16 v[52:55], v[80:83], v[88:91], v[52:55]
    ds_read_b64_tr_b16 v[124:125], v37 offset:8192
    ds_read_b64_tr_b16 v[126:127], v37 offset:9216
    ds_read_b64_tr_b16 v[128:129], v38 offset:8192
    v_mfma_f32_16x16x32_bf16 v[56:59], v[80:83], v[92:95], v[56:59]
    ds_read_b64_tr_b16 v[130:131], v38 offset:9216
    ds_read_b64_tr_b16 v[132:133], v39 offset:8192
    ds_read_b64_tr_b16 v[134:135], v39 offset:9216
    v_mfma_f32_16x16x32_bf16 v[60:63], v[80:83], v[96:99], v[60:63]
    ds_read_b64_tr_b16 v[136:137], v40 offset:8192
    ds_read_b64_tr_b16 v[138:139], v40 offset:9216
    ds_read_b64_tr_b16 v[140:141], v41 offset:8192
    v_mfma_f32_16x16x32_bf16 v[64:67], v[80:83], v[100:103], v[64:67]
    ds_read_b64_tr_b16 v[142:143], v41 offset:9216
    ds_read_b64_tr_b16 v[144:145], v42 offset:8192
    ds_read_b64_tr_b16 v[146:147], v42 offset:9216
    v_mfma_f32_16x16x32_bf16 v[68:71], v[80:83], v[104:107], v[68:71]
    ds_read_b64_tr_b16 v[148:149], v43 offset:8192
    ds_read_b64_tr_b16 v[150:151], v43 offset:9216
    v_mfma_f32_16x16x32_bf16 v[72:75], v[80:83], v[108:111], v[72:75]
    v_mfma_f32_16x16x32_bf16 v[76:79], v[80:83], v[112:115], v[76:79]
    s_waitcnt lgkmcnt(0)
    v_mfma_f32_16x16x32_bf16 v[48:51], v[116:119], v[120:123], v[48:51]
    v_mfma_f32_16x16x32_bf16 v[52:55], v[116:119], v[124:127], v[52:55]
    v_mfma_f32_16x16x32_bf16 v[56:59], v[116:119], v[128:131], v[56:59]
    v_mfma_f32_16x16x32_bf16 v[60:63], v[116:119], v[132:135], v[60:63]
    v_mfma_f32_16x16x32_bf16 v[64:67], v[116:119], v[136:139], v[64:67]
    v_mfma_f32_16x16x32_bf16 v[68:71], v[116:119], v[140:143], v[68:71]
    v_mfma_f32_16x16x32_bf16 v[72:75], v[116:119], v[144:147], v[72:75]
    v_mfma_f32_16x16x32_bf16 v[76:79], v[116:119], v[148:151], v[76:79]
    s_nop 7
    s_nop 1
    s_mov_b32 s40, 0x3fb8aa3b
    s_mov_b32 s41, 0x358637bd
    v_mul_f32 v80, s40, v48
    v_mul_f32 v81, s40, v49
    v_mul_f32 v82, s40, v50
    v_mul_f32 v83, s40, v51
    v_min_f32 v80, 0, v80
    v_min_f32 v81, 0, v81
    v_min_f32 v82, 0, v82
    v_min_f32 v83, 0, v83
    v_exp_f32 v80, v80
    v_exp_f32 v81, v81
    v_exp_f32 v82, v82
    v_exp_f32 v83, v83
    v_max_f32 v48, 0, v48
    v_max_f32 v49, 0, v49
    v_max_f32 v50, 0, v50
    v_max_f32 v51, 0, v51
    v_add_f32 v48, v48, v80
    v_add_f32 v49, v49, v81
    v_add_f32 v50, v50, v82
    v_add_f32 v51, v51, v83
    v_add_f32 v48, s41, v48
    v_add_f32 v49, s41, v49
    v_add_f32 v50, s41, v50
    v_add_f32 v51, s41, v51
    v_mul_f32 v80, s40, v52
    v_mul_f32 v81, s40, v53
    v_mul_f32 v82, s40, v54
    v_mul_f32 v83, s40, v55
    v_min_f32 v80, 0, v80
    v_min_f32 v81, 0, v81
    v_min_f32 v82, 0, v82
    v_min_f32 v83, 0, v83
    v_exp_f32 v80, v80
    v_exp_f32 v81, v81
    v_exp_f32 v82, v82
    v_exp_f32 v83, v83
    v_max_f32 v52, 0, v52
    v_max_f32 v53, 0, v53
    v_max_f32 v54, 0, v54
    v_max_f32 v55, 0, v55
    v_add_f32 v52, v52, v80
    v_add_f32 v53, v53, v81
    v_add_f32 v54, v54, v82
    v_add_f32 v55, v55, v83
    v_add_f32 v52, s41, v52
    v_add_f32 v53, s41, v53
    v_add_f32 v54, s41, v54
    v_add_f32 v55, s41, v55
    v_mul_f32 v80, s40, v56
    v_mul_f32 v81, s40, v57
    v_mul_f32 v82, s40, v58
    v_mul_f32 v83, s40, v59
    v_min_f32 v80, 0, v80
    v_min_f32 v81, 0, v81
    v_min_f32 v82, 0, v82
    v_min_f32 v83, 0, v83
    v_exp_f32 v80, v80
    v_exp_f32 v81, v81
    v_exp_f32 v82, v82
    v_exp_f32 v83, v83
    v_max_f32 v56, 0, v56
    v_max_f32 v57, 0, v57
    v_max_f32 v58, 0, v58
    v_max_f32 v59, 0, v59
    v_add_f32 v56, v56, v80
    v_add_f32 v57, v57, v81
    v_add_f32 v58, v58, v82
    v_add_f32 v59, v59, v83
    v_add_f32 v56, s41, v56
    v_add_f32 v57, s41, v57
    v_add_f32 v58, s41, v58
    v_add_f32 v59, s41, v59
    v_mul_f32 v80, s40, v60
    v_mul_f32 v81, s40, v61
    v_mul_f32 v82, s40, v62
    v_mul_f32 v83, s40, v63
    v_min_f32 v80, 0, v80
    v_min_f32 v81, 0, v81
    v_min_f32 v82, 0, v82
    v_min_f32 v83, 0, v83
    v_exp_f32 v80, v80
    v_exp_f32 v81, v81
    v_exp_f32 v82, v82
    v_exp_f32 v83, v83
    v_max_f32 v60, 0, v60
    v_max_f32 v61, 0, v61
    v_max_f32 v62, 0, v62
    v_max_f32 v63, 0, v63
    v_add_f32 v60, v60, v80
    v_add_f32 v61, v61, v81
    v_add_f32 v62, v62, v82
    v_add_f32 v63, v63, v83
    v_add_f32 v60, s41, v60
    v_add_f32 v61, s41, v61
    v_add_f32 v62, s41, v62
    v_add_f32 v63, s41, v63
    v_mul_f32 v80, s40, v64
    v_mul_f32 v81, s40, v65
    v_mul_f32 v82, s40, v66
    v_mul_f32 v83, s40, v67
    v_min_f32 v80, 0, v80
    v_min_f32 v81, 0, v81
    v_min_f32 v82, 0, v82
    v_min_f32 v83, 0, v83
    v_exp_f32 v80, v80
    v_exp_f32 v81, v81
    v_exp_f32 v82, v82
    v_exp_f32 v83, v83
    v_max_f32 v64, 0, v64
    v_max_f32 v65, 0, v65
    v_max_f32 v66, 0, v66
    v_max_f32 v67, 0, v67
    v_add_f32 v64, v64, v80
    v_add_f32 v65, v65, v81
    v_add_f32 v66, v66, v82
    v_add_f32 v67, v67, v83
    v_add_f32 v64, s41, v64
    v_add_f32 v65, s41, v65
    v_add_f32 v66, s41, v66
    v_add_f32 v67, s41, v67
    v_and_b32 v2, 15, v1
    v_lshrrev_b32 v3, 4, v1
    v_cmp_le_u32 vcc, 8, v2
    s_nop 1
    v_cndmask_b32 v76, v76, 1.0, vcc
    v_cndmask_b32 v77, v77, 1.0, vcc
    v_cndmask_b32 v78, v78, 1.0, vcc
    v_cndmask_b32 v79, v79, 1.0, vcc
    v_cvt_pk_bf16_f32 v84, v48, v49
    v_cvt_pk_bf16_f32 v85, v50, v51
    v_cvt_pk_bf16_f32 v86, v52, v53
    v_cvt_pk_bf16_f32 v87, v54, v55
    v_cvt_pk_bf16_f32 v88, v56, v57
    v_cvt_pk_bf16_f32 v89, v58, v59
    v_cvt_pk_bf16_f32 v90, v60, v61
    v_cvt_pk_bf16_f32 v91, v62, v63
    v_cvt_pk_bf16_f32 v92, v64, v65
    v_cvt_pk_bf16_f32 v93, v66, v67
    v_cvt_pk_bf16_f32 v94, v68, v69
    v_cvt_pk_bf16_f32 v95, v70, v71
    v_cvt_pk_bf16_f32 v96, v72, v73
    v_cvt_pk_bf16_f32 v97, v74, v75
    v_cvt_pk_bf16_f32 v98, v76, v77
    v_cvt_pk_bf16_f32 v99, v78, v79
    s_nop 1
    v_mfma_f32_16x16x16_bf16 v[104:107], v[88:89], v[94:95], 0
    v_mfma_f32_16x16x16_bf16 v[108:111], v[88:89], v[96:97], 0
    v_mfma_f32_16x16x16_bf16 v[112:115], v[88:89], v[98:99], 0
    v_mfma_f32_16x16x16_bf16 v[116:119], v[90:91], v[94:95], 0
    v_mfma_f32_16x16x16_bf16 v[120:123], v[90:91], v[96:97], 0
    v_mfma_f32_16x16x16_bf16 v[124:127], v[90:91], v[98:99], 0
    v_mfma_f32_16x16x16_bf16 v[128:131], v[92:93], v[94:95], 0
    v_mfma_f32_16x16x16_bf16 v[132:135], v[92:93], v[96:97], 0
    v_mfma_f32_16x16x16_bf16 v[136:139], v[92:93], v[98:99], 0
    s_lshl_b32 s32, s24, 4
    v_lshl_add_u32 v8, v3, 2, s32
    v_mul_u32_u24 v8, 80, v8
    v_lshl_add_u32 v8, v2, 1, v8
    ds_write_b16 v8, v84 offset:0
    ds_write_b16_d16_hi v8, v84 offset:80
    ds_write_b16 v8, v85 offset:160
    ds_write_b16_d16_hi v8, v85 offset:240
    ds_write_b16 v8, v86 offset:32
    ds_write_b16_d16_hi v8, v86 offset:112
    ds_write_b16 v8, v87 offset:192
    ds_write_b16_d16_hi v8, v87 offset:272
    v_cmp_gt_u32 vcc, 8, v2
    s_and_saveexec_b64 s[36:37], vcc
    ds_write_b16 v8, v88 offset:64
    ds_write_b16_d16_hi v8, v88 offset:144
    ds_write_b16 v8, v89 offset:224
    ds_write_b16_d16_hi v8, v89 offset:304
    s_mov_b64 exec, s[36:37]
    v_add_u32 v10, 0, v1
    v_mul_u32_u24 v11, 0x3334, v10
    v_lshrrev_b32 v11, 16, v11
    v_mul_u32_u24 v4, 5, v11
    v_sub_u32 v4, v10, v4
    v_add_u32 v5, s32, v11
    v_mul_u32_u24 v146, 80, v5
    v_lshl_add_u32 v146, v4, 4, v146
    s_lshl_b32 s33, s25, 7
    v_add_u32 v5, s33, v5
    v_mul_u32_u24 v5, 1280, v5
    v_lshl_add_u32 v5, v4, 4, v5
    s_xor_b32 s33, s26, 1
    s_mul_i32 s33, s33, 80
    v_add_u32 v144, s33, v5
    v_add_u32 v10, 64, v1
    v_mul_u32_u24 v11, 0x3334, v10
    v_lshrrev_b32 v11, 16, v11
    v_mul_u32_u24 v4, 5, v11
    v_sub_u32 v4, v10, v4
    v_add_u32 v5, s32, v11
    v_mul_u32_u24 v147, 80, v5
    v_lshl_add_u32 v147, v4, 4, v147
    s_lshl_b32 s33, s25, 7
    v_add_u32 v5, s33, v5
    v_mul_u32_u24 v5, 1280, v5
    v_lshl_add_u32 v5, v4, 4, v5
    s_xor_b32 s33, s26, 1
    s_mul_i32 s33, s33, 80
    v_add_u32 v145, s33, v5
    s_mul_i32 s33, s24, 9216
    s_add_u32 s33, s33, 16384
    v_lshlrev_b32 v9, 2, v3
    v_mul_u32_u24 v9, 192, v9
    v_lshl_add_u32 v9, v2, 2, v9
    v_add_u32 v9, s33, v9
    s_waitcnt lgkmcnt(0)
    ds_read_b128 v[148:151], v146
    v_cmp_gt_u32 vcc, 16, v1
    s_and_saveexec_b64 s[36:37], vcc
    ds_read_b128 v[152:155], v147
    s_mov_b64 exec, s[36:37]
    ds_write_b32 v9, v104 offset:0
    ds_write_b32 v9, v105 offset:192
    ds_write_b32 v9, v106 offset:384
    ds_write_b32 v9, v107 offset:576
    ds_write_b32 v9, v108 offset:64
    ds_write_b32 v9, v109 offset:256
    ds_write_b32 v9, v110 offset:448
    ds_write_b32 v9, v111 offset:640
    ds_write_b32 v9, v112 offset:128
    ds_write_b32 v9, v113 offset:320
    ds_write_b32 v9, v114 offset:512
    ds_write_b32 v9, v115 offset:704
    ds_write_b32 v9, v116 offset:3072
    ds_write_b32 v9, v117 offset:3264
    ds_write_b32 v9, v118 offset:3456
    ds_write_b32 v9, v119 offset:3648
    ds_write_b32 v9, v120 offset:3136
    ds_write_b32 v9, v121 offset:3328
    ds_write_b32 v9, v122 offset:3520
    ds_write_b32 v9, v123 offset:3712
    ds_write_b32 v9, v124 offset:3200
    ds_write_b32 v9, v125 offset:3392
    ds_write_b32 v9, v126 offset:3584
    ds_write_b32 v9, v127 offset:3776
    ds_write_b32 v9, v128 offset:6144
    ds_write_b32 v9, v129 offset:6336
    ds_write_b32 v9, v130 offset:6528
    ds_write_b32 v9, v131 offset:6720
    ds_write_b32 v9, v132 offset:6208
    ds_write_b32 v9, v133 offset:6400
    ds_write_b32 v9, v134 offset:6592
    ds_write_b32 v9, v135 offset:6784
    ds_write_b32 v9, v136 offset:6272
    ds_write_b32 v9, v137 offset:6464
    ds_write_b32 v9, v138 offset:6656
    ds_write_b32 v9, v139 offset:6848
    s_waitcnt lgkmcnt(0)
    s_barrier
    buffer_store_dwordx4 v[148:151], v144, s[20:23], 0 offen
    v_cmp_gt_u32 vcc, 16, v1
    s_and_saveexec_b64 s[36:37], vcc
    buffer_store_dwordx4 v[152:155], v145, s[20:23], 0 offen
    s_mov_b64 exec, s[36:37]
    v_cmp_gt_u32 vcc, 160, v0
    s_and_saveexec_b64 s[36:37], vcc
    s_cbranch_execz K1_FIN
    v_lshrrev_b32 v2, 2, v0
    v_and_b32 v3, 3, v0
    v_cmp_le_u32 vcc, 20, v2
    s_nop 1
    v_cndmask_b32 v8, 0, 1, vcc
    v_add_u32 v9, 8, v2
    v_mul_u32_u24 v9, 192, v9
    v_mul_u32_u24 v10, 20, v8
    v_mul_u32_u24 v11, 5, v3
    v_add_u32 v10, v10, v11
    v_lshl_add_u32 v12, v10, 2, v9
    v_add_u32 v12, 16384, v12
    v_add_u32 v13, 16544, v9
    ds_read_b32 v48, v12 offset:0
    ds_read_b32 v49, v12 offset:4
    ds_read_b32 v50, v12 offset:8
    ds_read_b32 v51, v12 offset:12
    ds_read_b32 v52, v12 offset:16
    ds_read_b32 v53, v13 offset:0
    ds_read_b32 v54, v12 offset:9216
    ds_read_b32 v55, v12 offset:9220
    ds_read_b32 v56, v12 offset:9224
    ds_read_b32 v57, v12 offset:9228
    ds_read_b32 v58, v12 offset:9232
    ds_read_b32 v59, v13 offset:9216
    ds_read_b32 v60, v12 offset:18432
    ds_read_b32 v61, v12 offset:18436
    ds_read_b32 v62, v12 offset:18440
    ds_read_b32 v63, v12 offset:18444
    ds_read_b32 v64, v12 offset:18448
    ds_read_b32 v65, v13 offset:18432
    ds_read_b32 v66, v12 offset:27648
    ds_read_b32 v67, v12 offset:27652
    ds_read_b32 v68, v12 offset:27656
    ds_read_b32 v69, v12 offset:27660
    ds_read_b32 v70, v12 offset:27664
    ds_read_b32 v71, v13 offset:27648
    ds_read_b32 v72, v12 offset:36864
    ds_read_b32 v73, v12 offset:36868
    ds_read_b32 v74, v12 offset:36872
    ds_read_b32 v75, v12 offset:36876
    ds_read_b32 v76, v12 offset:36880
    ds_read_b32 v77, v13 offset:36864
    ds_read_b32 v78, v12 offset:46080
    ds_read_b32 v79, v12 offset:46084
    ds_read_b32 v80, v12 offset:46088
    ds_read_b32 v81, v12 offset:46092
    ds_read_b32 v82, v12 offset:46096
    ds_read_b32 v83, v13 offset:46080
    ds_read_b32 v84, v12 offset:55296
    ds_read_b32 v85, v12 offset:55300
    ds_read_b32 v86, v12 offset:55304
    ds_read_b32 v87, v12 offset:55308
    ds_read_b32 v88, v12 offset:55312
    ds_read_b32 v89, v13 offset:55296
    ds_read_b32 v90, v12 offset:64512
    ds_read_b32 v91, v12 offset:64516
    ds_read_b32 v92, v12 offset:64520
    ds_read_b32 v93, v12 offset:64524
    ds_read_b32 v94, v12 offset:64528
    ds_read_b32 v95, v13 offset:64512
    s_waitcnt lgkmcnt(0)
    v_add_f32 v48, v48, v72
    v_add_f32 v49, v49, v73
    v_add_f32 v50, v50, v74
    v_add_f32 v51, v51, v75
    v_add_f32 v52, v52, v76
    v_add_f32 v53, v53, v77
    v_add_f32 v54, v54, v78
    v_add_f32 v55, v55, v79
    v_add_f32 v56, v56, v80
    v_add_f32 v57, v57, v81
    v_add_f32 v58, v58, v82
    v_add_f32 v59, v59, v83
    v_add_f32 v60, v60, v84
    v_add_f32 v61, v61, v85
    v_add_f32 v62, v62, v86
    v_add_f32 v63, v63, v87
    v_add_f32 v64, v64, v88
    v_add_f32 v65, v65, v89
    v_add_f32 v66, v66, v90
    v_add_f32 v67, v67, v91
    v_add_f32 v68, v68, v92
    v_add_f32 v69, v69, v93
    v_add_f32 v70, v70, v94
    v_add_f32 v71, v71, v95
    v_add_f32 v48, v48, v60
    v_add_f32 v49, v49, v61
    v_add_f32 v50, v50, v62
    v_add_f32 v51, v51, v63
    v_add_f32 v52, v52, v64
    v_add_f32 v53, v53, v65
    v_add_f32 v54, v54, v66
    v_add_f32 v55, v55, v67
    v_add_f32 v56, v56, v68
    v_add_f32 v57, v57, v69
    v_add_f32 v58, v58, v70
    v_add_f32 v59, v59, v71
    v_add_f32 v48, v48, v54
    v_add_f32 v49, v49, v55
    v_add_f32 v50, v50, v56
    v_add_f32 v51, v51, v57
    v_add_f32 v52, v52, v58
    v_add_f32 v53, v53, v59
    s_lshl_b32 s33, s25, 5
    s_lshl_b32 s34, s26, 1
    s_add_u32 s33, s33, s34
    s_mul_i32 s33, s33, 1600
    s_add_u32 s33, s33, 0x5c8000
    v_mul_u32_u24 v9, 20, v2
    v_add_u32 v9, v9, v11
    v_lshl_add_u32 v9, v9, 2, s33
    buffer_store_dword v48, v9, s[20:23], 0 offen offset:0
    buffer_store_dword v49, v9, s[20:23], 0 offen offset:4
    buffer_store_dword v50, v9, s[20:23], 0 offen offset:8
    buffer_store_dword v51, v9, s[20:23], 0 offen offset:12
    buffer_store_dword v52, v9, s[20:23], 0 offen offset:16
    s_mul_i32 s33, s25, 2560
    s_mul_i32 s34, s26, 160
    s_add_u32 s33, s33, s34
    s_add_u32 s33, s33, 0x690000
    v_lshl_add_u32 v9, v2, 2, s33
    v_cmp_eq_u32 vcc, 0, v3
    s_and_b64 exec, exec, vcc
    buffer_store_dword v53, v9, s[20:23], 0 offen
K1_FIN:
    s_mov_b64 exec, s[36:37]
K1_END:
    s_endpgm
.p2align 8
k2_kernel:
    s_cmp_ge_u32 s2, 256
    s_cbranch_scc1 K2_END
    s_load_dwordx2 s[4:5], s[0:1], 16
    s_load_dwordx2 s[8:9], s[0:1], 40
    s_lshr_b32 s24, s2, 3
    s_and_b32 s25, s2, 7
    v_lshlrev_b32 v1, 2, v0
    v_lshrrev_b32 v2, 8, v0
    s_nop 0
    v_readfirstlane_b32 s26, v2
    v_and_b32 v10, 255, v0
    s_waitcnt lgkmcnt(0)
    s_mov_b32 s12, s4
    s_and_b32 s13, s5, 0xffff
    s_mov_b32 s14, 0xc8000
    s_mov_b32 s15, 0x00020000
    s_mov_b32 s20, s8
    s_and_b32 s21, s9, 0xffff
    s_mov_b32 s22, 0x69a000
    s_mov_b32 s23, 0x00020000
    s_mov_b32 s30, 0x690000
    buffer_load_dword v16, v1, s[20:23], s30 offen
    s_mov_b32 s30, 0x690a00
    buffer_load_dword v17, v1, s[20:23], s30 offen
    s_mov_b32 s30, 0x691400
    buffer_load_dword v18, v1, s[20:23], s30 offen
    s_mov_b32 s30, 0x691e00
    buffer_load_dword v19, v1, s[20:23], s30 offen
    s_mov_b32 s30, 0x692800
    buffer_load_dword v20, v1, s[20:23], s30 offen
    s_mov_b32 s30, 0x693200
    buffer_load_dword v21, v1, s[20:23], s30 offen
    s_mov_b32 s30, 0x693c00
    buffer_load_dword v22, v1, s[20:23], s30 offen
    s_mov_b32 s30, 0x694600
    buffer_load_dword v23, v1, s[20:23], s30 offen
    s_mov_b32 s30, 0x695000
    buffer_load_dword v24, v1, s[20:23], s30 offen
    s_mov_b32 s30, 0x695a00
    buffer_load_dword v25, v1, s[20:23], s30 offen
    s_mov_b32 s30, 0x696400
    buffer_load_dword v26, v1, s[20:23], s30 offen
    s_mov_b32 s30, 0x696e00
    buffer_load_dword v27, v1, s[20:23], s30 offen
    s_mov_b32 s30, 0x697800
    buffer_load_dword v28, v1, s[20:23], s30 offen
    s_mov_b32 s30, 0x698200
    buffer_load_dword v29, v1, s[20:23], s30 offen
    s_mov_b32 s30, 0x698c00
    buffer_load_dword v30, v1, s[20:23], s30 offen
    s_mov_b32 s30, 0x699600
    buffer_load_dword v31, v1, s[20:23], s30 offen
    s_mov_b32 s30, 0x690800
    buffer_load_dword v32, v1, s[20:23], s30 offen
    s_mov_b32 s30, 0x691200
    buffer_load_dword v33, v1, s[20:23], s30 offen
    s_mov_b32 s30, 0x691c00
    buffer_load_dword v34, v1, s[20:23], s30 offen
    s_mov_b32 s30, 0x692600
    buffer_load_dword v35, v1, s[20:23], s30 offen
    s_mov_b32 s30, 0x693000
    buffer_load_dword v36, v1, s[20:23], s30 offen
    s_mov_b32 s30, 0x693a00
    buffer_load_dword v37, v1, s[20:23], s30 offen
    s_mov_b32 s30, 0x694400
    buffer_load_dword v38, v1, s[20:23], s30 offen
    s_mov_b32 s30, 0x694e00
    buffer_load_dword v39, v1, s[20:23], s30 offen
    s_mov_b32 s30, 0x695800
    buffer_load_dword v40, v1, s[20:23], s30 offen
    s_mov_b32 s30, 0x696200
    buffer_load_dword v41, v1, s[20:23], s30 offen
    s_mov_b32 s30, 0x696c00
    buffer_load_dword v42, v1, s[20:23], s30 offen
    s_mov_b32 s30, 0x697600
    buffer_load_dword v43, v1, s[20:23], s30 offen
    s_mov_b32 s30, 0x698000
    buffer_load_dword v44, v1, s[20:23], s30 offen
    s_mov_b32 s30, 0x698a00
    buffer_load_dword v45, v1, s[20:23], s30 offen
    s_mov_b32 s30, 0x699400
    buffer_load_dword v46, v1, s[20:23], s30 offen
    s_mov_b32 s30, 0x699e00
    buffer_load_dword v47, v1, s[20:23], s30 offen
    s_mul_i32 s31, s24, 1600
    s_add_u32 s31, s31, 0x5c8000
    s_add_u32 s30, s31, 0x0
    buffer_load_dword v48, v1, s[20:23], s30 offen
    s_add_u32 s30, s31, 0xc800
    buffer_load_dword v49, v1, s[20:23], s30 offen
    s_add_u32 s30, s31, 0x19000
    buffer_load_dword v50, v1, s[20:23], s30 offen
    s_add_u32 s30, s31, 0x25800
    buffer_load_dword v51, v1, s[20:23], s30 offen
    s_add_u32 s30, s31, 0x32000
    buffer_load_dword v52, v1, s[20:23], s30 offen
    s_add_u32 s30, s31, 0x3e800
    buffer_load_dword v53, v1, s[20:23], s30 offen
    s_add_u32 s30, s31, 0x4b000
    buffer_load_dword v54, v1, s[20:23], s30 offen
    s_add_u32 s30, s31, 0x57800
    buffer_load_dword v55, v1, s[20:23], s30 offen
    s_add_u32 s30, s31, 0x64000
    buffer_load_dword v56, v1, s[20:23], s30 offen
    s_add_u32 s30, s31, 0x70800
    buffer_load_dword v57, v1, s[20:23], s30 offen
    s_add_u32 s30, s31, 0x7d000
    buffer_load_dword v58, v1, s[20:23], s30 offen
    s_add_u32 s30, s31, 0x89800
    buffer_load_dword v59, v1, s[20:23], s30 offen
    s_add_u32 s30, s31, 0x96000
    buffer_load_dword v60, v1, s[20:23], s30 offen
    s_add_u32 s30, s31, 0xa2800
    buffer_load_dword v61, v1, s[20:23], s30 offen
    s_add_u32 s30, s31, 0xaf000
    buffer_load_dword v62, v1, s[20:23], s30 offen
    s_add_u32 s30, s31, 0xbb800
    buffer_load_dword v63, v1, s[20:23], s30 offen
    s_cmp_eq_u32 s26, 0
    s_cbranch_scc0 K2_LD_SCALE
    v_mul_u32_u24 v2, 0x667, v10
    v_lshrrev_b32 v2, 16, v2
    v_mul_u32_u24 v3, 40, v2
    v_sub_u32 v3, v10, v3
    v_min_u32 v2, 4, v2
    s_mul_i32 s30, s24, 25600
    s_mul_i32 s31, s25, 160
    s_add_u32 s30, s30, s31
    v_lshlrev_b32 v4, 2, v3
    v_add_u32 v4, s30, v4
    s_mov_b32 s31, 0
    buffer_load_dword v100, v4, s[12:15], s31 offen
    s_mov_b32 s31, 1280
    buffer_load_dword v101, v4, s[12:15], s31 offen
    s_mov_b32 s31, 2560
    buffer_load_dword v102, v4, s[12:15], s31 offen
    s_mov_b32 s31, 3840
    buffer_load_dword v103, v4, s[12:15], s31 offen
    s_mov_b32 s31, 5120
    buffer_load_dword v104, v4, s[12:15], s31 offen
    s_mov_b32 s31, 6400
    buffer_load_dword v105, v4, s[12:15], s31 offen
    s_mov_b32 s31, 7680
    buffer_load_dword v106, v4, s[12:15], s31 offen
    s_mov_b32 s31, 8960
    buffer_load_dword v107, v4, s[12:15], s31 offen
    s_mov_b32 s31, 10240
    buffer_load_dword v108, v4, s[12:15], s31 offen
    s_mov_b32 s31, 11520
    buffer_load_dword v109, v4, s[12:15], s31 offen
    s_mov_b32 s31, 12800
    buffer_load_dword v110, v4, s[12:15], s31 offen
    s_mov_b32 s31, 14080
    buffer_load_dword v111, v4, s[12:15], s31 offen
    s_mov_b32 s31, 15360
    buffer_load_dword v112, v4, s[12:15], s31 offen
    s_mov_b32 s31, 16640
    buffer_load_dword v113, v4, s[12:15], s31 offen
    s_mov_b32 s31, 17920
    buffer_load_dword v114, v4, s[12:15], s31 offen
    s_mov_b32 s31, 19200
    buffer_load_dword v115, v4, s[12:15], s31 offen
    s_mov_b32 s31, 20480
    buffer_load_dword v116, v4, s[12:15], s31 offen
    s_mov_b32 s31, 21760
    buffer_load_dword v117, v4, s[12:15], s31 offen
    s_mov_b32 s31, 23040
    buffer_load_dword v118, v4, s[12:15], s31 offen
    s_mov_b32 s31, 24320
    buffer_load_dword v119, v4, s[12:15], s31 offen
    s_waitcnt vmcnt(20)
    s_branch K2_RED
K2_LD_SCALE:
    v_lshrrev_b32 v5, 5, v10
    s_lshl_b32 s30, s2, 3
    v_add_u32 v5, s30, v5
    v_mul_u32_u24 v5, 1280, v5
    v_and_b32 v6, 31, v10
    v_mul_u32_u24 v7, 40, v6
    v_add_u32 v5, v5, v7
    buffer_load_dwordx2 v[120:121], v5, s[20:23], 0 offen offset:0
    buffer_load_dwordx2 v[122:123], v5, s[20:23], 0 offen offset:8
    buffer_load_dwordx2 v[124:125], v5, s[20:23], 0 offen offset:16
    buffer_load_dwordx2 v[126:127], v5, s[20:23], 0 offen offset:24
    buffer_load_dwordx2 v[128:129], v5, s[20:23], 0 offen offset:32
    s_waitcnt vmcnt(5)
K2_RED:
    v_add_f32 v16, v16, v24
    v_add_f32 v17, v17, v25
    v_add_f32 v18, v18, v26
    v_add_f32 v19, v19, v27
    v_add_f32 v20, v20, v28
    v_add_f32 v21, v21, v29
    v_add_f32 v22, v22, v30
    v_add_f32 v23, v23, v31
    v_add_f32 v16, v16, v20
    v_add_f32 v17, v17, v21
    v_add_f32 v18, v18, v22
    v_add_f32 v19, v19, v23
    v_add_f32 v16, v16, v18
    v_add_f32 v17, v17, v19
    v_add_f32 v16, v16, v17
    v_cvt_pk_bf16_f32 v8, v16, v16
    v_lshlrev_b32 v16, 16, v8
    v_add_f32 v32, v32, v40
    v_add_f32 v33, v33, v41
    v_add_f32 v34, v34, v42
    v_add_f32 v35, v35, v43
    v_add_f32 v36, v36, v44
    v_add_f32 v37, v37, v45
    v_add_f32 v38, v38, v46
    v_add_f32 v39, v39, v47
    v_add_f32 v32, v32, v36
    v_add_f32 v33, v33, v37
    v_add_f32 v34, v34, v38
    v_add_f32 v35, v35, v39
    v_add_f32 v32, v32, v34
    v_add_f32 v33, v33, v35
    v_add_f32 v32, v32, v33
    v_cvt_pk_bf16_f32 v8, v32, v32
    v_lshlrev_b32 v32, 16, v8
    v_add_f32 v48, v48, v56
    v_add_f32 v49, v49, v57
    v_add_f32 v50, v50, v58
    v_add_f32 v51, v51, v59
    v_add_f32 v52, v52, v60
    v_add_f32 v53, v53, v61
    v_add_f32 v54, v54, v62
    v_add_f32 v55, v55, v63
    v_add_f32 v48, v48, v52
    v_add_f32 v49, v49, v53
    v_add_f32 v50, v50, v54
    v_add_f32 v51, v51, v55
    v_add_f32 v48, v48, v50
    v_add_f32 v49, v49, v51
    v_add_f32 v48, v48, v49
    v_cvt_pk_bf16_f32 v8, v48, v48
    v_lshlrev_b32 v48, 16, v8
    ds_write_b32 v1, v16
    v_cmp_gt_u32 vcc, 128, v0
    s_and_saveexec_b64 s[36:37], vcc
    ds_write_b32 v1, v32 offset:2048
    s_mov_b64 exec, s[36:37]
    v_cmp_gt_u32 vcc, 400, v0
    s_and_saveexec_b64 s[36:37], vcc
    ds_write_b32 v1, v48 offset:4096
    s_mov_b64 exec, s[36:37]
    s_waitcnt lgkmcnt(0)
    s_barrier
    s_cmp_eq_u32 s26, 0
    s_cbranch_scc0 K2_SCALE
    v_mov_b32 v140, 0
    v_mov_b32 v141, 0
    v_mov_b32 v142, 0
    v_mov_b32 v143, 0
    v_mov_b32 v144, 0
    v_mov_b32 v145, 0
    v_mov_b32 v146, 0
    v_mov_b32 v147, 0
    v_mul_u32_u24 v8, 320, v2
    ds_read_b128 v[160:163], v8 offset:4096
    ds_read_b128 v[164:167], v8 offset:4112
    ds_read_b128 v[168:171], v8 offset:4128
    ds_read_b128 v[172:175], v8 offset:4144
    ds_read_b128 v[176:179], v8 offset:4160
    ds_read_b128 v[180:183], v8 offset:4176
    ds_read_b128 v[184:187], v8 offset:4192
    ds_read_b128 v[188:191], v8 offset:4208
    ds_read_b128 v[192:195], v8 offset:4224
    ds_read_b128 v[196:199], v8 offset:4240
    ds_read_b128 v[200:203], v8 offset:4256
    ds_read_b128 v[204:207], v8 offset:4272
    ds_read_b128 v[208:211], v8 offset:4288
    ds_read_b128 v[212:215], v8 offset:4304
    ds_read_b128 v[216:219], v8 offset:4320
    ds_read_b128 v[220:223], v8 offset:4336
    ds_read_b128 v[224:227], v8 offset:4352
    ds_read_b128 v[228:231], v8 offset:4368
    ds_read_b128 v[232:235], v8 offset:4384
    ds_read_b128 v[236:239], v8 offset:4400
    s_waitcnt vmcnt(0)
    v_lshlrev_b32 v16, 16, v100
    v_and_b32 v36, 0xffff0000, v100
    v_lshlrev_b32 v17, 16, v101
    v_and_b32 v37, 0xffff0000, v101
    v_lshlrev_b32 v18, 16, v102
    v_and_b32 v38, 0xffff0000, v102
    v_lshlrev_b32 v19, 16, v103
    v_and_b32 v39, 0xffff0000, v103
    v_lshlrev_b32 v20, 16, v104
    v_and_b32 v40, 0xffff0000, v104
    v_lshlrev_b32 v21, 16, v105
    v_and_b32 v41, 0xffff0000, v105
    v_lshlrev_b32 v22, 16, v106
    v_and_b32 v42, 0xffff0000, v106
    v_lshlrev_b32 v23, 16, v107
    v_and_b32 v43, 0xffff0000, v107
    v_lshlrev_b32 v24, 16, v108
    v_and_b32 v44, 0xffff0000, v108
    v_lshlrev_b32 v25, 16, v109
    v_and_b32 v45, 0xffff0000, v109
    v_lshlrev_b32 v26, 16, v110
    v_and_b32 v46, 0xffff0000, v110
    v_lshlrev_b32 v27, 16, v111
    v_and_b32 v47, 0xffff0000, v111
    v_lshlrev_b32 v28, 16, v112
    v_and_b32 v48, 0xffff0000, v112
    v_lshlrev_b32 v29, 16, v113
    v_and_b32 v49, 0xffff0000, v113
    v_lshlrev_b32 v30, 16, v114
    v_and_b32 v50, 0xffff0000, v114
    v_lshlrev_b32 v31, 16, v115
    v_and_b32 v51, 0xffff0000, v115
    v_lshlrev_b32 v32, 16, v116
    v_and_b32 v52, 0xffff0000, v116
    v_lshlrev_b32 v33, 16, v117
    v_and_b32 v53, 0xffff0000, v117
    v_lshlrev_b32 v34, 16, v118
    v_and_b32 v54, 0xffff0000, v118
    v_lshlrev_b32 v35, 16, v119
    v_and_b32 v55, 0xffff0000, v119
    s_waitcnt lgkmcnt(0)
    v_fmac_f32 v140, v160, v16
    v_fmac_f32 v141, v160, v36
    v_fmac_f32 v140, v161, v17
    v_fmac_f32 v141, v161, v37
    v_fmac_f32 v140, v162, v18
    v_fmac_f32 v141, v162, v38
    v_fmac_f32 v140, v163, v19
    v_fmac_f32 v141, v163, v39
    v_fmac_f32 v140, v164, v20
    v_fmac_f32 v141, v164, v40
    v_fmac_f32 v140, v165, v21
    v_fmac_f32 v141, v165, v41
    v_fmac_f32 v140, v166, v22
    v_fmac_f32 v141, v166, v42
    v_fmac_f32 v140, v167, v23
    v_fmac_f32 v141, v167, v43
    v_fmac_f32 v140, v168, v24
    v_fmac_f32 v141, v168, v44
    v_fmac_f32 v140, v169, v25
    v_fmac_f32 v141, v169, v45
    v_fmac_f32 v140, v170, v26
    v_fmac_f32 v141, v170, v46
    v_fmac_f32 v140, v171, v27
    v_fmac_f32 v141, v171, v47
    v_fmac_f32 v140, v172, v28
    v_fmac_f32 v141, v172, v48
    v_fmac_f32 v140, v173, v29
    v_fmac_f32 v141, v173, v49
    v_fmac_f32 v140, v174, v30
    v_fmac_f32 v141, v174, v50
    v_fmac_f32 v140, v175, v31
    v_fmac_f32 v141, v175, v51
    v_fmac_f32 v140, v176, v32
    v_fmac_f32 v141, v176, v52
    v_fmac_f32 v140, v177, v33
    v_fmac_f32 v141, v177, v53
    v_fmac_f32 v140, v178, v34
    v_fmac_f32 v141, v178, v54
    v_fmac_f32 v140, v179, v35
    v_fmac_f32 v141, v179, v55
    v_fmac_f32 v142, v180, v16
    v_fmac_f32 v143, v180, v36
    v_fmac_f32 v142, v181, v17
    v_fmac_f32 v143, v181, v37
    v_fmac_f32 v142, v182, v18
    v_fmac_f32 v143, v182, v38
    v_fmac_f32 v142, v183, v19
    v_fmac_f32 v143, v183, v39
    v_fmac_f32 v142, v184, v20
    v_fmac_f32 v143, v184, v40
    v_fmac_f32 v142, v185, v21
    v_fmac_f32 v143, v185, v41
    v_fmac_f32 v142, v186, v22
    v_fmac_f32 v143, v186, v42
    v_fmac_f32 v142, v187, v23
    v_fmac_f32 v143, v187, v43
    v_fmac_f32 v142, v188, v24
    v_fmac_f32 v143, v188, v44
    v_fmac_f32 v142, v189, v25
    v_fmac_f32 v143, v189, v45
    v_fmac_f32 v142, v190, v26
    v_fmac_f32 v143, v190, v46
    v_fmac_f32 v142, v191, v27
    v_fmac_f32 v143, v191, v47
    v_fmac_f32 v142, v192, v28
    v_fmac_f32 v143, v192, v48
    v_fmac_f32 v142, v193, v29
    v_fmac_f32 v143, v193, v49
    v_fmac_f32 v142, v194, v30
    v_fmac_f32 v143, v194, v50
    v_fmac_f32 v142, v195, v31
    v_fmac_f32 v143, v195, v51
    v_fmac_f32 v142, v196, v32
    v_fmac_f32 v143, v196, v52
    v_fmac_f32 v142, v197, v33
    v_fmac_f32 v143, v197, v53
    v_fmac_f32 v142, v198, v34
    v_fmac_f32 v143, v198, v54
    v_fmac_f32 v142, v199, v35
    v_fmac_f32 v143, v199, v55
    v_fmac_f32 v144, v200, v16
    v_fmac_f32 v145, v200, v36
    v_fmac_f32 v144, v201, v17
    v_fmac_f32 v145, v201, v37
    v_fmac_f32 v144, v202, v18
    v_fmac_f32 v145, v202, v38
    v_fmac_f32 v144, v203, v19
    v_fmac_f32 v145, v203, v39
    v_fmac_f32 v144, v204, v20
    v_fmac_f32 v145, v204, v40
    v_fmac_f32 v144, v205, v21
    v_fmac_f32 v145, v205, v41
    v_fmac_f32 v144, v206, v22
    v_fmac_f32 v145, v206, v42
    v_fmac_f32 v144, v207, v23
    v_fmac_f32 v145, v207, v43
    v_fmac_f32 v144, v208, v24
    v_fmac_f32 v145, v208, v44
    v_fmac_f32 v144, v209, v25
    v_fmac_f32 v145, v209, v45
    v_fmac_f32 v144, v210, v26
    v_fmac_f32 v145, v210, v46
    v_fmac_f32 v144, v211, v27
    v_fmac_f32 v145, v211, v47
    v_fmac_f32 v144, v212, v28
    v_fmac_f32 v145, v212, v48
    v_fmac_f32 v144, v213, v29
    v_fmac_f32 v145, v213, v49
    v_fmac_f32 v144, v214, v30
    v_fmac_f32 v145, v214, v50
    v_fmac_f32 v144, v215, v31
    v_fmac_f32 v145, v215, v51
    v_fmac_f32 v144, v216, v32
    v_fmac_f32 v145, v216, v52
    v_fmac_f32 v144, v217, v33
    v_fmac_f32 v145, v217, v53
    v_fmac_f32 v144, v218, v34
    v_fmac_f32 v145, v218, v54
    v_fmac_f32 v144, v219, v35
    v_fmac_f32 v145, v219, v55
    v_fmac_f32 v146, v220, v16
    v_fmac_f32 v147, v220, v36
    v_fmac_f32 v146, v221, v17
    v_fmac_f32 v147, v221, v37
    v_fmac_f32 v146, v222, v18
    v_fmac_f32 v147, v222, v38
    v_fmac_f32 v146, v223, v19
    v_fmac_f32 v147, v223, v39
    v_fmac_f32 v146, v224, v20
    v_fmac_f32 v147, v224, v40
    v_fmac_f32 v146, v225, v21
    v_fmac_f32 v147, v225, v41
    v_fmac_f32 v146, v226, v22
    v_fmac_f32 v147, v226, v42
    v_fmac_f32 v146, v227, v23
    v_fmac_f32 v147, v227, v43
    v_fmac_f32 v146, v228, v24
    v_fmac_f32 v147, v228, v44
    v_fmac_f32 v146, v229, v25
    v_fmac_f32 v147, v229, v45
    v_fmac_f32 v146, v230, v26
    v_fmac_f32 v147, v230, v46
    v_fmac_f32 v146, v231, v27
    v_fmac_f32 v147, v231, v47
    v_fmac_f32 v146, v232, v28
    v_fmac_f32 v147, v232, v48
    v_fmac_f32 v146, v233, v29
    v_fmac_f32 v147, v233, v49
    v_fmac_f32 v146, v234, v30
    v_fmac_f32 v147, v234, v50
    v_fmac_f32 v146, v235, v31
    v_fmac_f32 v147, v235, v51
    v_fmac_f32 v146, v236, v32
    v_fmac_f32 v147, v236, v52
    v_fmac_f32 v146, v237, v33
    v_fmac_f32 v147, v237, v53
    v_fmac_f32 v146, v238, v34
    v_fmac_f32 v147, v238, v54
    v_fmac_f32 v146, v239, v35
    v_fmac_f32 v147, v239, v55
    v_cvt_pk_bf16_f32 v150, v140, v141
    v_cvt_pk_bf16_f32 v151, v142, v143
    v_cvt_pk_bf16_f32 v152, v144, v145
    v_cvt_pk_bf16_f32 v153, v146, v147
    s_mul_i32 s30, s25, 102400
    s_mul_i32 s31, s24, 3200
    s_add_u32 s30, s30, s31
    s_add_u32 s30, s30, 0x500000
    v_mul_u32_u24 v8, 640, v2
    v_lshl_add_u32 v8, v3, 2, v8
    v_add_u32 v8, s30, v8
    v_cmp_gt_u32 vcc, 200, v10
    s_and_saveexec_b64 s[36:37], vcc
    buffer_store_dword v150, v8, s[20:23], 0 offen offset:0
    buffer_store_dword v151, v8, s[20:23], 0 offen offset:160
    buffer_store_dword v152, v8, s[20:23], 0 offen offset:320
    buffer_store_dword v153, v8, s[20:23], 0 offen offset:480
    s_mov_b64 exec, s[36:37]
    s_branch K2_FIN
K2_SCALE:
    v_mul_u32_u24 v8, 80, v6
    ds_read_b128 v[160:163], v8 offset:0
    ds_read_b128 v[164:167], v8 offset:16
    ds_read_b128 v[168:171], v8 offset:32
    ds_read_b128 v[172:175], v8 offset:48
    ds_read_b128 v[176:179], v8 offset:64
    s_waitcnt vmcnt(0)
    v_lshlrev_b32 v200, 16, v120
    v_and_b32 v201, 0xffff0000, v120
    v_lshlrev_b32 v202, 16, v121
    v_and_b32 v203, 0xffff0000, v121
    v_lshlrev_b32 v204, 16, v122
    v_and_b32 v205, 0xffff0000, v122
    v_lshlrev_b32 v206, 16, v123
    v_and_b32 v207, 0xffff0000, v123
    v_lshlrev_b32 v208, 16, v124
    v_and_b32 v209, 0xffff0000, v124
    v_lshlrev_b32 v210, 16, v125
    v_and_b32 v211, 0xffff0000, v125
    v_lshlrev_b32 v212, 16, v126
    v_and_b32 v213, 0xffff0000, v126
    v_lshlrev_b32 v214, 16, v127
    v_and_b32 v215, 0xffff0000, v127
    v_lshlrev_b32 v216, 16, v128
    v_and_b32 v217, 0xffff0000, v128
    v_lshlrev_b32 v218, 16, v129
    v_and_b32 v219, 0xffff0000, v129
    s_waitcnt lgkmcnt(0)
    v_mov_b32 v9, 0x358637bd
    v_fmac_f32 v9, v200, v160
    v_fmac_f32 v9, v201, v161
    v_fmac_f32 v9, v202, v162
    v_fmac_f32 v9, v203, v163
    v_fmac_f32 v9, v204, v164
    v_fmac_f32 v9, v205, v165
    v_fmac_f32 v9, v206, v166
    v_fmac_f32 v9, v207, v167
    v_fmac_f32 v9, v208, v168
    v_fmac_f32 v9, v209, v169
    v_fmac_f32 v9, v210, v170
    v_fmac_f32 v9, v211, v171
    v_fmac_f32 v9, v212, v172
    v_fmac_f32 v9, v213, v173
    v_fmac_f32 v9, v214, v174
    v_fmac_f32 v9, v215, v175
    v_fmac_f32 v9, v216, v176
    v_fmac_f32 v9, v217, v177
    v_fmac_f32 v9, v218, v178
    v_fmac_f32 v9, v219, v179
    v_rcp_f32 v9, v9
    s_nop 0
    v_mul_f32 v200, v9, v200
    v_mul_f32 v201, v9, v201
    v_mul_f32 v202, v9, v202
    v_mul_f32 v203, v9, v203
    v_mul_f32 v204, v9, v204
    v_mul_f32 v205, v9, v205
    v_mul_f32 v206, v9, v206
    v_mul_f32 v207, v9, v207
    v_mul_f32 v208, v9, v208
    v_mul_f32 v209, v9, v209
    v_mul_f32 v210, v9, v210
    v_mul_f32 v211, v9, v211
    v_mul_f32 v212, v9, v212
    v_mul_f32 v213, v9, v213
    v_mul_f32 v214, v9, v214
    v_mul_f32 v215, v9, v215
    v_mul_f32 v216, v9, v216
    v_mul_f32 v217, v9, v217
    v_mul_f32 v218, v9, v218
    v_mul_f32 v219, v9, v219
    v_cvt_pk_bf16_f32 v120, v200, v201
    v_cvt_pk_bf16_f32 v121, v202, v203
    v_cvt_pk_bf16_f32 v122, v204, v205
    v_cvt_pk_bf16_f32 v123, v206, v207
    v_cvt_pk_bf16_f32 v124, v208, v209
    v_cvt_pk_bf16_f32 v125, v210, v211
    v_cvt_pk_bf16_f32 v126, v212, v213
    v_cvt_pk_bf16_f32 v127, v214, v215
    v_cvt_pk_bf16_f32 v128, v216, v217
    v_cvt_pk_bf16_f32 v129, v218, v219
    v_add_u32 v5, 0x280000, v5
    buffer_store_dwordx2 v[120:121], v5, s[20:23], 0 offen offset:0
    buffer_store_dwordx2 v[122:123], v5, s[20:23], 0 offen offset:8
    buffer_store_dwordx2 v[124:125], v5, s[20:23], 0 offen offset:16
    buffer_store_dwordx2 v[126:127], v5, s[20:23], 0 offen offset:24
    buffer_store_dwordx2 v[128:129], v5, s[20:23], 0 offen offset:32
K2_FIN:
K2_END:
    s_endpgm
.p2align 8
k3_kernel:
    s_cmp_ge_u32 s2, 256
    s_cbranch_scc1 K3_END
    s_load_dwordx2 s[4:5], s[0:1], 24
    s_load_dwordx2 s[8:9], s[0:1], 40
    s_and_b32 s30, s2, 7
    s_lshr_b32 s31, s2, 3
    s_lshr_b32 s25, s30, 1
    s_lshl_b32 s25, s25, 3
    s_and_b32 s32, s31, 7
    s_add_u32 s25, s25, s32
    s_and_b32 s26, s30, 1
    s_lshl_b32 s26, s26, 2
    s_lshr_b32 s32, s31, 3
    s_add_u32 s26, s26, s32
    v_lshrrev_b32 v2, 6, v0
    v_and_b32 v1, 63, v0
    s_nop 0
    v_readfirstlane_b32 s24, v2
    v_lshrrev_b32 v3, 4, v1
    v_mul_u32_u24 v2, 1280, v3
    v_and_b32 v8, 15, v1
    v_add_u32 v9, 0, v3
    v_xor_b32 v9, v8, v9
    v_lshl_add_u32 v4, v9, 4, v2
    v_add_u32 v9, 4, v3
    v_xor_b32 v9, v8, v9
    v_lshl_add_u32 v5, v9, 4, v2
    v_add_u32 v9, 8, v3
    v_xor_b32 v9, v8, v9
    v_lshl_add_u32 v6, v9, 4, v2
    v_add_u32 v9, 12, v3
    v_xor_b32 v9, v8, v9
    v_lshl_add_u32 v7, v9, 4, v2
    s_nop 0
    s_mul_i32 s32, s24, 384
    s_mov_b32 s33, 43691
    v_add_u32 v14, s32, v1
    v_add_u32 v14, 0, v14
    v_mul_lo_u32 v15, v14, s33
    v_lshrrev_b32 v15, 19, v15
    v_mul_u32_u24 v16, 12, v15
    v_sub_u32 v16, v14, v16
    v_bfe_u32 v17, v15, 3, 1
    v_lshlrev_b32 v17, 1, v17
    v_xor_b32 v16, v16, v17
    v_min_u32 v16, 9, v16
    v_mul_u32_u24 v15, 160, v15
    v_lshl_add_u32 v8, v16, 4, v15
    v_add_u32 v14, s32, v1
    v_add_u32 v14, 64, v14
    v_mul_lo_u32 v15, v14, s33
    v_lshrrev_b32 v15, 19, v15
    v_mul_u32_u24 v16, 12, v15
    v_sub_u32 v16, v14, v16
    v_bfe_u32 v17, v15, 3, 1
    v_lshlrev_b32 v17, 1, v17
    v_xor_b32 v16, v16, v17
    v_min_u32 v16, 9, v16
    v_mul_u32_u24 v15, 160, v15
    v_lshl_add_u32 v9, v16, 4, v15
    v_add_u32 v14, s32, v1
    v_add_u32 v14, 128, v14
    v_mul_lo_u32 v15, v14, s33
    v_lshrrev_b32 v15, 19, v15
    v_mul_u32_u24 v16, 12, v15
    v_sub_u32 v16, v14, v16
    v_bfe_u32 v17, v15, 3, 1
    v_lshlrev_b32 v17, 1, v17
    v_xor_b32 v16, v16, v17
    v_min_u32 v16, 9, v16
    v_mul_u32_u24 v15, 160, v15
    v_lshl_add_u32 v10, v16, 4, v15
    v_add_u32 v14, s32, v1
    v_add_u32 v14, 192, v14
    v_mul_lo_u32 v15, v14, s33
    v_lshrrev_b32 v15, 19, v15
    v_mul_u32_u24 v16, 12, v15
    v_sub_u32 v16, v14, v16
    v_bfe_u32 v17, v15, 3, 1
    v_lshlrev_b32 v17, 1, v17
    v_xor_b32 v16, v16, v17
    v_min_u32 v16, 9, v16
    v_mul_u32_u24 v15, 160, v15
    v_lshl_add_u32 v11, v16, 4, v15
    v_add_u32 v14, s32, v1
    v_add_u32 v14, 256, v14
    v_mul_lo_u32 v15, v14, s33
    v_lshrrev_b32 v15, 19, v15
    v_mul_u32_u24 v16, 12, v15
    v_sub_u32 v16, v14, v16
    v_bfe_u32 v17, v15, 3, 1
    v_lshlrev_b32 v17, 1, v17
    v_xor_b32 v16, v16, v17
    v_min_u32 v16, 9, v16
    v_mul_u32_u24 v15, 160, v15
    v_lshl_add_u32 v12, v16, 4, v15
    v_add_u32 v14, s32, v1
    v_add_u32 v14, 320, v14
    v_mul_lo_u32 v15, v14, s33
    v_lshrrev_b32 v15, 19, v15
    v_mul_u32_u24 v16, 12, v15
    v_sub_u32 v16, v14, v16
    v_bfe_u32 v17, v15, 3, 1
    v_lshlrev_b32 v17, 1, v17
    v_xor_b32 v16, v16, v17
    v_min_u32 v16, 9, v16
    v_mul_u32_u24 v15, 160, v15
    v_lshl_add_u32 v13, v16, 4, v15
    v_and_b32 v2, 15, v1
    v_lshrrev_b32 v3, 4, v1
    s_lshl_b32 s32, s24, 4
    v_add_u32 v14, s32, v2
    v_lshlrev_b32 v14, 8, v14
    v_add_u32 v15, 0, v3
    v_xor_b32 v15, v15, v2
    v_lshl_add_u32 v16, v15, 4, v14
    v_add_u32 v20, 0x14000, v16
    v_add_u32 v15, 4, v3
    v_xor_b32 v15, v15, v2
    v_lshl_add_u32 v17, v15, 4, v14
    v_add_u32 v21, 0x14000, v17
    v_add_u32 v15, 8, v3
    v_xor_b32 v15, v15, v2
    v_lshl_add_u32 v18, v15, 4, v14
    v_add_u32 v22, 0x14000, v18
    v_add_u32 v15, 12, v3
    v_xor_b32 v15, v15, v2
    v_lshl_add_u32 v19, v15, 4, v14
    v_add_u32 v23, 0x14000, v19
    v_lshrrev_b32 v14, 2, v2
    v_lshl_add_u32 v14, v3, 3, v14
    v_mul_u32_u24 v14, 192, v14
    v_add_u32 v14, 16384, v14
    v_and_b32 v15, 1, v1
    v_lshl_add_u32 v14, v15, 3, v14
    v_and_b32 v15, 1, v3
    v_lshlrev_b32 v15, 1, v15
    v_bfe_u32 v34, v1, 1, 1
    v_add_u32 v35, 0, v34
    v_xor_b32 v35, v35, v15
    v_lshl_add_u32 v24, v35, 4, v14
    v_add_u32 v29, 0x14000, v24
    v_add_u32 v35, 2, v34
    v_xor_b32 v35, v35, v15
    v_lshl_add_u32 v25, v35, 4, v14
    v_add_u32 v30, 0x14000, v25
    v_add_u32 v35, 4, v34
    v_xor_b32 v35, v35, v15
    v_lshl_add_u32 v26, v35, 4, v14
    v_add_u32 v31, 0x14000, v26
    v_add_u32 v35, 6, v34
    v_xor_b32 v35, v35, v15
    v_lshl_add_u32 v27, v35, 4, v14
    v_add_u32 v32, 0x14000, v27
    v_add_u32 v35, 8, v34
    v_xor_b32 v35, v35, v15
    v_lshl_add_u32 v28, v35, 4, v14
    v_add_u32 v33, 0x14000, v28
    s_waitcnt lgkmcnt(0)
    s_mov_b32 s12, s4
    s_and_b32 s13, s5, 0xffff
    s_mov_b32 s14, 0x280000
    s_mov_b32 s15, 0x00020000
    s_mov_b32 s20, s8
    s_and_b32 s21, s9, 0xffff
    s_mov_b32 s22, 0x69a000
    s_mov_b32 s23, 0x00020000
    s_lshl_b32 s30, s25, 6
    s_lshl_b32 s31, s24, 4
    s_add_u32 s30, s30, s31
    s_mul_i32 s27, s30, 1280
    s_add_u32 s27, s27, 0x280000
    s_mul_i32 s28, s26, 102400
    s_add_u32 s28, s28, 0x500000
    s_lshl_b32 s29, s24, 12
    s_mul_i32 s35, s24, 6144
    v_mov_b32 v64, 0
    v_mov_b32 v65, 0
    v_mov_b32 v66, 0
    v_mov_b32 v67, 0
    v_mov_b32 v68, 0
    v_mov_b32 v69, 0
    v_mov_b32 v70, 0
    v_mov_b32 v71, 0
    v_mov_b32 v72, 0
    v_mov_b32 v73, 0
    v_mov_b32 v74, 0
    v_mov_b32 v75, 0
    v_mov_b32 v76, 0
    v_mov_b32 v77, 0
    v_mov_b32 v78, 0
    v_mov_b32 v79, 0
    v_mov_b32 v80, 0
    v_mov_b32 v81, 0
    v_mov_b32 v82, 0
    v_mov_b32 v83, 0
    s_add_u32 m0, s29, 0x0
    s_add_u32 s33, s27, 0x0
    buffer_load_dwordx4 v4, s[20:23], s33 offen lds
    s_add_u32 m0, s29, 0x400
    s_add_u32 s33, s27, 0x1400
    buffer_load_dwordx4 v5, s[20:23], s33 offen lds
    s_add_u32 m0, s29, 0x800
    s_add_u32 s33, s27, 0x2800
    buffer_load_dwordx4 v6, s[20:23], s33 offen lds
    s_add_u32 m0, s29, 0xc00
    s_add_u32 s33, s27, 0x3c00
    buffer_load_dwordx4 v7, s[20:23], s33 offen lds
    s_add_u32 m0, s35, 0x4000
    s_add_u32 s34, s28, 0x0
    buffer_load_dwordx4 v8, s[20:23], s34 offen lds
    s_add_u32 m0, s35, 0x4400
    s_add_u32 s34, s28, 0x0
    buffer_load_dwordx4 v9, s[20:23], s34 offen lds
    s_add_u32 m0, s35, 0x4800
    s_add_u32 s34, s28, 0x0
    buffer_load_dwordx4 v10, s[20:23], s34 offen lds
    s_add_u32 m0, s35, 0x4c00
    s_add_u32 s34, s28, 0x0
    buffer_load_dwordx4 v11, s[20:23], s34 offen lds
    s_add_u32 m0, s35, 0x5000
    s_add_u32 s34, s28, 0x0
    buffer_load_dwordx4 v12, s[20:23], s34 offen lds
    s_add_u32 m0, s35, 0x5400
    s_add_u32 s34, s28, 0x0
    buffer_load_dwordx4 v13, s[20:23], s34 offen lds
    s_add_u32 m0, s29, 0xa000
    s_add_u32 s33, s27, 0x100
    buffer_load_dwordx4 v4, s[20:23], s33 offen lds
    s_add_u32 m0, s29, 0xa400
    s_add_u32 s33, s27, 0x1500
    buffer_load_dwordx4 v5, s[20:23], s33 offen lds
    s_add_u32 m0, s29, 0xa800
    s_add_u32 s33, s27, 0x2900
    buffer_load_dwordx4 v6, s[20:23], s33 offen lds
    s_add_u32 m0, s29, 0xac00
    s_add_u32 s33, s27, 0x3d00
    buffer_load_dwordx4 v7, s[20:23], s33 offen lds
    s_add_u32 m0, s35, 0xe000
    s_add_u32 s34, s28, 0x5000
    buffer_load_dwordx4 v8, s[20:23], s34 offen lds
    s_add_u32 m0, s35, 0xe400
    s_add_u32 s34, s28, 0x5000
    buffer_load_dwordx4 v9, s[20:23], s34 offen lds
    s_add_u32 m0, s35, 0xe800
    s_add_u32 s34, s28, 0x5000
    buffer_load_dwordx4 v10, s[20:23], s34 offen lds
    s_add_u32 m0, s35, 0xec00
    s_add_u32 s34, s28, 0x5000
    buffer_load_dwordx4 v11, s[20:23], s34 offen lds
    s_add_u32 m0, s35, 0xf000
    s_add_u32 s34, s28, 0x5000
    buffer_load_dwordx4 v12, s[20:23], s34 offen lds
    s_add_u32 m0, s35, 0xf400
    s_add_u32 s34, s28, 0x5000
    buffer_load_dwordx4 v13, s[20:23], s34 offen lds
    s_add_u32 m0, s29, 0x14000
    s_add_u32 s33, s27, 0x200
    buffer_load_dwordx4 v4, s[20:23], s33 offen lds
    s_add_u32 m0, s29, 0x14400
    s_add_u32 s33, s27, 0x1600
    buffer_load_dwordx4 v5, s[20:23], s33 offen lds
    s_add_u32 m0, s29, 0x14800
    s_add_u32 s33, s27, 0x2a00
    buffer_load_dwordx4 v6, s[20:23], s33 offen lds
    s_add_u32 m0, s29, 0x14c00
    s_add_u32 s33, s27, 0x3e00
    buffer_load_dwordx4 v7, s[20:23], s33 offen lds
    s_add_u32 m0, s35, 0x18000
    s_add_u32 s34, s28, 0xa000
    buffer_load_dwordx4 v8, s[20:23], s34 offen lds
    s_add_u32 m0, s35, 0x18400
    s_add_u32 s34, s28, 0xa000
    buffer_load_dwordx4 v9, s[20:23], s34 offen lds
    s_add_u32 m0, s35, 0x18800
    s_add_u32 s34, s28, 0xa000
    buffer_load_dwordx4 v10, s[20:23], s34 offen lds
    s_add_u32 m0, s35, 0x18c00
    s_add_u32 s34, s28, 0xa000
    buffer_load_dwordx4 v11, s[20:23], s34 offen lds
    s_add_u32 m0, s35, 0x19000
    s_add_u32 s34, s28, 0xa000
    buffer_load_dwordx4 v12, s[20:23], s34 offen lds
    s_add_u32 m0, s35, 0x19400
    s_add_u32 s34, s28, 0xa000
    buffer_load_dwordx4 v13, s[20:23], s34 offen lds
    s_add_u32 m0, s29, 0x1e000
    s_add_u32 s33, s27, 0x300
    buffer_load_dwordx4 v4, s[20:23], s33 offen lds
    s_add_u32 m0, s29, 0x1e400
    s_add_u32 s33, s27, 0x1700
    buffer_load_dwordx4 v5, s[20:23], s33 offen lds
    s_add_u32 m0, s29, 0x1e800
    s_add_u32 s33, s27, 0x2b00
    buffer_load_dwordx4 v6, s[20:23], s33 offen lds
    s_add_u32 m0, s29, 0x1ec00
    s_add_u32 s33, s27, 0x3f00
    buffer_load_dwordx4 v7, s[20:23], s33 offen lds
    s_add_u32 m0, s35, 0x22000
    s_add_u32 s34, s28, 0xf000
    buffer_load_dwordx4 v8, s[20:23], s34 offen lds
    s_add_u32 m0, s35, 0x22400
    s_add_u32 s34, s28, 0xf000
    buffer_load_dwordx4 v9, s[20:23], s34 offen lds
    s_add_u32 m0, s35, 0x22800
    s_add_u32 s34, s28, 0xf000
    buffer_load_dwordx4 v10, s[20:23], s34 offen lds
    s_add_u32 m0, s35, 0x22c00
    s_add_u32 s34, s28, 0xf000
    buffer_load_dwordx4 v11, s[20:23], s34 offen lds
    s_add_u32 m0, s35, 0x23000
    s_add_u32 s34, s28, 0xf000
    buffer_load_dwordx4 v12, s[20:23], s34 offen lds
    s_add_u32 m0, s35, 0x23400
    s_add_u32 s34, s28, 0xf000
    buffer_load_dwordx4 v13, s[20:23], s34 offen lds
    s_waitcnt vmcnt(30)
    s_barrier
    ds_read_b128 v[96:99], v16 offset:0
    ds_read_b64_tr_b16 v[100:101], v24 offset:0
    ds_read_b64_tr_b16 v[102:103], v24 offset:768
    ds_read_b64_tr_b16 v[104:105], v25 offset:0
    ds_read_b64_tr_b16 v[106:107], v25 offset:768
    ds_read_b64_tr_b16 v[108:109], v26 offset:0
    ds_read_b64_tr_b16 v[110:111], v26 offset:768
    ds_read_b64_tr_b16 v[112:113], v27 offset:0
    ds_read_b64_tr_b16 v[114:115], v27 offset:768
    ds_read_b64_tr_b16 v[116:117], v28 offset:0
    ds_read_b64_tr_b16 v[118:119], v28 offset:768
    s_waitcnt lgkmcnt(0)
    v_mfma_f32_16x16x32_bf16 v[64:67], v[96:99], v[100:103], v[64:67]
    ds_read_b128 v[120:123], v17 offset:0
    ds_read_b64_tr_b16 v[124:125], v24 offset:6144
    ds_read_b64_tr_b16 v[126:127], v24 offset:6912
    v_mfma_f32_16x16x32_bf16 v[68:71], v[96:99], v[104:107], v[68:71]
    ds_read_b64_tr_b16 v[128:129], v25 offset:6144
    ds_read_b64_tr_b16 v[130:131], v25 offset:6912
    ds_read_b64_tr_b16 v[132:133], v26 offset:6144
    v_mfma_f32_16x16x32_bf16 v[72:75], v[96:99], v[108:111], v[72:75]
    ds_read_b64_tr_b16 v[134:135], v26 offset:6912
    ds_read_b64_tr_b16 v[136:137], v27 offset:6144
    ds_read_b64_tr_b16 v[138:139], v27 offset:6912
    v_mfma_f32_16x16x32_bf16 v[76:79], v[96:99], v[112:115], v[76:79]
    ds_read_b64_tr_b16 v[140:141], v28 offset:6144
    ds_read_b64_tr_b16 v[142:143], v28 offset:6912
    v_mfma_f32_16x16x32_bf16 v[80:83], v[96:99], v[116:119], v[80:83]
    s_waitcnt lgkmcnt(0)
    v_mfma_f32_16x16x32_bf16 v[64:67], v[120:123], v[124:127], v[64:67]
    ds_read_b128 v[96:99], v18 offset:0
    ds_read_b64_tr_b16 v[100:101], v24 offset:12288
    ds_read_b64_tr_b16 v[102:103], v24 offset:13056
    v_mfma_f32_16x16x32_bf16 v[68:71], v[120:123], v[128:131], v[68:71]
    ds_read_b64_tr_b16 v[104:105], v25 offset:12288
    ds_read_b64_tr_b16 v[106:107], v25 offset:13056
    ds_read_b64_tr_b16 v[108:109], v26 offset:12288
    v_mfma_f32_16x16x32_bf16 v[72:75], v[120:123], v[132:135], v[72:75]
    ds_read_b64_tr_b16 v[110:111], v26 offset:13056
    ds_read_b64_tr_b16 v[112:113], v27 offset:12288
    ds_read_b64_tr_b16 v[114:115], v27 offset:13056
    v_mfma_f32_16x16x32_bf16 v[76:79], v[120:123], v[136:139], v[76:79]
    ds_read_b64_tr_b16 v[116:117], v28 offset:12288
    ds_read_b64_tr_b16 v[118:119], v28 offset:13056
    v_mfma_f32_16x16x32_bf16 v[80:83], v[120:123], v[140:143], v[80:83]
    s_waitcnt lgkmcnt(0)
    v_mfma_f32_16x16x32_bf16 v[64:67], v[96:99], v[100:103], v[64:67]
    ds_read_b128 v[120:123], v19 offset:0
    ds_read_b64_tr_b16 v[124:125], v24 offset:18432
    ds_read_b64_tr_b16 v[126:127], v24 offset:19200
    v_mfma_f32_16x16x32_bf16 v[68:71], v[96:99], v[104:107], v[68:71]
    ds_read_b64_tr_b16 v[128:129], v25 offset:18432
    ds_read_b64_tr_b16 v[130:131], v25 offset:19200
    ds_read_b64_tr_b16 v[132:133], v26 offset:18432
    v_mfma_f32_16x16x32_bf16 v[72:75], v[96:99], v[108:111], v[72:75]
    ds_read_b64_tr_b16 v[134:135], v26 offset:19200
    ds_read_b64_tr_b16 v[136:137], v27 offset:18432
    ds_read_b64_tr_b16 v[138:139], v27 offset:19200
    v_mfma_f32_16x16x32_bf16 v[76:79], v[96:99], v[112:115], v[76:79]
    ds_read_b64_tr_b16 v[140:141], v28 offset:18432
    ds_read_b64_tr_b16 v[142:143], v28 offset:19200
    v_mfma_f32_16x16x32_bf16 v[80:83], v[96:99], v[116:119], v[80:83]
    s_waitcnt lgkmcnt(0)
    s_waitcnt vmcnt(20)
    s_barrier
    v_mfma_f32_16x16x32_bf16 v[64:67], v[120:123], v[124:127], v[64:67]
    ds_read_b128 v[96:99], v16 offset:40960
    ds_read_b64_tr_b16 v[100:101], v24 offset:40960
    ds_read_b64_tr_b16 v[102:103], v24 offset:41728
    v_mfma_f32_16x16x32_bf16 v[68:71], v[120:123], v[128:131], v[68:71]
    ds_read_b64_tr_b16 v[104:105], v25 offset:40960
    ds_read_b64_tr_b16 v[106:107], v25 offset:41728
    ds_read_b64_tr_b16 v[108:109], v26 offset:40960
    v_mfma_f32_16x16x32_bf16 v[72:75], v[120:123], v[132:135], v[72:75]
    ds_read_b64_tr_b16 v[110:111], v26 offset:41728
    ds_read_b64_tr_b16 v[112:113], v27 offset:40960
    ds_read_b64_tr_b16 v[114:115], v27 offset:41728
    v_mfma_f32_16x16x32_bf16 v[76:79], v[120:123], v[136:139], v[76:79]
    ds_read_b64_tr_b16 v[116:117], v28 offset:40960
    ds_read_b64_tr_b16 v[118:119], v28 offset:41728
    v_mfma_f32_16x16x32_bf16 v[80:83], v[120:123], v[140:143], v[80:83]
    s_add_u32 m0, s29, 0x0
    s_add_u32 s33, s27, 0x400
    buffer_load_dwordx4 v4, s[20:23], s33 offen lds
    s_add_u32 m0, s29, 0x400
    s_add_u32 s33, s27, 0x1800
    buffer_load_dwordx4 v5, s[20:23], s33 offen lds
    s_add_u32 m0, s29, 0x800
    s_add_u32 s33, s27, 0x2c00
    buffer_load_dwordx4 v6, s[20:23], s33 offen lds
    s_add_u32 m0, s29, 0xc00
    s_add_u32 s33, s27, 0x4000
    buffer_load_dwordx4 v7, s[20:23], s33 offen lds
    s_add_u32 m0, s35, 0x4000
    s_add_u32 s34, s28, 0x14000
    buffer_load_dwordx4 v8, s[20:23], s34 offen lds
    s_add_u32 m0, s35, 0x4400
    s_add_u32 s34, s28, 0x14000
    buffer_load_dwordx4 v9, s[20:23], s34 offen lds
    s_add_u32 m0, s35, 0x4800
    s_add_u32 s34, s28, 0x14000
    buffer_load_dwordx4 v10, s[20:23], s34 offen lds
    s_add_u32 m0, s35, 0x4c00
    s_add_u32 s34, s28, 0x14000
    buffer_load_dwordx4 v11, s[20:23], s34 offen lds
    s_add_u32 m0, s35, 0x5000
    s_add_u32 s34, s28, 0x14000
    buffer_load_dwordx4 v12, s[20:23], s34 offen lds
    s_add_u32 m0, s35, 0x5400
    s_add_u32 s34, s28, 0x14000
    buffer_load_dwordx4 v13, s[20:23], s34 offen lds
    s_waitcnt lgkmcnt(0)
    v_mfma_f32_16x16x32_bf16 v[64:67], v[96:99], v[100:103], v[64:67]
    ds_read_b128 v[120:123], v17 offset:40960
    ds_read_b64_tr_b16 v[124:125], v24 offset:47104
    ds_read_b64_tr_b16 v[126:127], v24 offset:47872
    v_mfma_f32_16x16x32_bf16 v[68:71], v[96:99], v[104:107], v[68:71]
    ds_read_b64_tr_b16 v[128:129], v25 offset:47104
    ds_read_b64_tr_b16 v[130:131], v25 offset:47872
    ds_read_b64_tr_b16 v[132:133], v26 offset:47104
    v_mfma_f32_16x16x32_bf16 v[72:75], v[96:99], v[108:111], v[72:75]
    ds_read_b64_tr_b16 v[134:135], v26 offset:47872
    ds_read_b64_tr_b16 v[136:137], v27 offset:47104
    ds_read_b64_tr_b16 v[138:139], v27 offset:47872
    v_mfma_f32_16x16x32_bf16 v[76:79], v[96:99], v[112:115], v[76:79]
    ds_read_b64_tr_b16 v[140:141], v28 offset:47104
    ds_read_b64_tr_b16 v[142:143], v28 offset:47872
    v_mfma_f32_16x16x32_bf16 v[80:83], v[96:99], v[116:119], v[80:83]
    s_waitcnt lgkmcnt(0)
    v_mfma_f32_16x16x32_bf16 v[64:67], v[120:123], v[124:127], v[64:67]
    ds_read_b128 v[96:99], v18 offset:40960
    ds_read_b64_tr_b16 v[100:101], v24 offset:53248
    ds_read_b64_tr_b16 v[102:103], v24 offset:54016
    v_mfma_f32_16x16x32_bf16 v[68:71], v[120:123], v[128:131], v[68:71]
    ds_read_b64_tr_b16 v[104:105], v25 offset:53248
    ds_read_b64_tr_b16 v[106:107], v25 offset:54016
    ds_read_b64_tr_b16 v[108:109], v26 offset:53248
    v_mfma_f32_16x16x32_bf16 v[72:75], v[120:123], v[132:135], v[72:75]
    ds_read_b64_tr_b16 v[110:111], v26 offset:54016
    ds_read_b64_tr_b16 v[112:113], v27 offset:53248
    ds_read_b64_tr_b16 v[114:115], v27 offset:54016
    v_mfma_f32_16x16x32_bf16 v[76:79], v[120:123], v[136:139], v[76:79]
    ds_read_b64_tr_b16 v[116:117], v28 offset:53248
    ds_read_b64_tr_b16 v[118:119], v28 offset:54016
    v_mfma_f32_16x16x32_bf16 v[80:83], v[120:123], v[140:143], v[80:83]
    s_waitcnt lgkmcnt(0)
    v_mfma_f32_16x16x32_bf16 v[64:67], v[96:99], v[100:103], v[64:67]
    ds_read_b128 v[120:123], v19 offset:40960
    ds_read_b64_tr_b16 v[124:125], v24 offset:59392
    ds_read_b64_tr_b16 v[126:127], v24 offset:60160
    v_mfma_f32_16x16x32_bf16 v[68:71], v[96:99], v[104:107], v[68:71]
    ds_read_b64_tr_b16 v[128:129], v25 offset:59392
    ds_read_b64_tr_b16 v[130:131], v25 offset:60160
    ds_read_b64_tr_b16 v[132:133], v26 offset:59392
    v_mfma_f32_16x16x32_bf16 v[72:75], v[96:99], v[108:111], v[72:75]
    ds_read_b64_tr_b16 v[134:135], v26 offset:60160
    ds_read_b64_tr_b16 v[136:137], v27 offset:59392
    ds_read_b64_tr_b16 v[138:139], v27 offset:60160
    v_mfma_f32_16x16x32_bf16 v[76:79], v[96:99], v[112:115], v[76:79]
    ds_read_b64_tr_b16 v[140:141], v28 offset:59392
    ds_read_b64_tr_b16 v[142:143], v28 offset:60160
    v_mfma_f32_16x16x32_bf16 v[80:83], v[96:99], v[116:119], v[80:83]
    s_waitcnt lgkmcnt(0)
    s_waitcnt vmcnt(20)
    s_barrier
    v_mfma_f32_16x16x32_bf16 v[64:67], v[120:123], v[124:127], v[64:67]
    ds_read_b128 v[96:99], v20 offset:0
    ds_read_b64_tr_b16 v[100:101], v29 offset:0
    ds_read_b64_tr_b16 v[102:103], v29 offset:768
    v_mfma_f32_16x16x32_bf16 v[68:71], v[120:123], v[128:131], v[68:71]
    ds_read_b64_tr_b16 v[104:105], v30 offset:0
    ds_read_b64_tr_b16 v[106:107], v30 offset:768
    ds_read_b64_tr_b16 v[108:109], v31 offset:0
    v_mfma_f32_16x16x32_bf16 v[72:75], v[120:123], v[132:135], v[72:75]
    ds_read_b64_tr_b16 v[110:111], v31 offset:768
    ds_read_b64_tr_b16 v[112:113], v32 offset:0
    ds_read_b64_tr_b16 v[114:115], v32 offset:768
    v_mfma_f32_16x16x32_bf16 v[76:79], v[120:123], v[136:139], v[76:79]
    ds_read_b64_tr_b16 v[116:117], v33 offset:0
    ds_read_b64_tr_b16 v[118:119], v33 offset:768
    v_mfma_f32_16x16x32_bf16 v[80:83], v[120:123], v[140:143], v[80:83]
    s_waitcnt lgkmcnt(0)
    v_mfma_f32_16x16x32_bf16 v[64:67], v[96:99], v[100:103], v[64:67]
    ds_read_b128 v[120:123], v21 offset:0
    ds_read_b64_tr_b16 v[124:125], v29 offset:6144
    ds_read_b64_tr_b16 v[126:127], v29 offset:6912
    v_mfma_f32_16x16x32_bf16 v[68:71], v[96:99], v[104:107], v[68:71]
    ds_read_b64_tr_b16 v[128:129], v30 offset:6144
    ds_read_b64_tr_b16 v[130:131], v30 offset:6912
    ds_read_b64_tr_b16 v[132:133], v31 offset:6144
    v_mfma_f32_16x16x32_bf16 v[72:75], v[96:99], v[108:111], v[72:75]
    ds_read_b64_tr_b16 v[134:135], v31 offset:6912
    ds_read_b64_tr_b16 v[136:137], v32 offset:6144
    ds_read_b64_tr_b16 v[138:139], v32 offset:6912
    v_mfma_f32_16x16x32_bf16 v[76:79], v[96:99], v[112:115], v[76:79]
    ds_read_b64_tr_b16 v[140:141], v33 offset:6144
    ds_read_b64_tr_b16 v[142:143], v33 offset:6912
    v_mfma_f32_16x16x32_bf16 v[80:83], v[96:99], v[116:119], v[80:83]
    s_waitcnt lgkmcnt(0)
    v_mfma_f32_16x16x32_bf16 v[64:67], v[120:123], v[124:127], v[64:67]
    ds_read_b128 v[96:99], v22 offset:0
    ds_read_b64_tr_b16 v[100:101], v29 offset:12288
    ds_read_b64_tr_b16 v[102:103], v29 offset:13056
    v_mfma_f32_16x16x32_bf16 v[68:71], v[120:123], v[128:131], v[68:71]
    ds_read_b64_tr_b16 v[104:105], v30 offset:12288
    ds_read_b64_tr_b16 v[106:107], v30 offset:13056
    ds_read_b64_tr_b16 v[108:109], v31 offset:12288
    v_mfma_f32_16x16x32_bf16 v[72:75], v[120:123], v[132:135], v[72:75]
    ds_read_b64_tr_b16 v[110:111], v31 offset:13056
    ds_read_b64_tr_b16 v[112:113], v32 offset:12288
    ds_read_b64_tr_b16 v[114:115], v32 offset:13056
    v_mfma_f32_16x16x32_bf16 v[76:79], v[120:123], v[136:139], v[76:79]
    ds_read_b64_tr_b16 v[116:117], v33 offset:12288
    ds_read_b64_tr_b16 v[118:119], v33 offset:13056
    v_mfma_f32_16x16x32_bf16 v[80:83], v[120:123], v[140:143], v[80:83]
    s_waitcnt lgkmcnt(0)
    v_mfma_f32_16x16x32_bf16 v[64:67], v[96:99], v[100:103], v[64:67]
    ds_read_b128 v[120:123], v23 offset:0
    ds_read_b64_tr_b16 v[124:125], v29 offset:18432
    ds_read_b64_tr_b16 v[126:127], v29 offset:19200
    v_mfma_f32_16x16x32_bf16 v[68:71], v[96:99], v[104:107], v[68:71]
    ds_read_b64_tr_b16 v[128:129], v30 offset:18432
    ds_read_b64_tr_b16 v[130:131], v30 offset:19200
    ds_read_b64_tr_b16 v[132:133], v31 offset:18432
    v_mfma_f32_16x16x32_bf16 v[72:75], v[96:99], v[108:111], v[72:75]
    ds_read_b64_tr_b16 v[134:135], v31 offset:19200
    ds_read_b64_tr_b16 v[136:137], v32 offset:18432
    ds_read_b64_tr_b16 v[138:139], v32 offset:19200
    v_mfma_f32_16x16x32_bf16 v[76:79], v[96:99], v[112:115], v[76:79]
    ds_read_b64_tr_b16 v[140:141], v33 offset:18432
    ds_read_b64_tr_b16 v[142:143], v33 offset:19200
    v_mfma_f32_16x16x32_bf16 v[80:83], v[96:99], v[116:119], v[80:83]
    s_waitcnt lgkmcnt(0)
    s_waitcnt vmcnt(10)
    s_barrier
    v_mfma_f32_16x16x32_bf16 v[64:67], v[120:123], v[124:127], v[64:67]
    ds_read_b128 v[96:99], v20 offset:40960
    ds_read_b64_tr_b16 v[100:101], v29 offset:40960
    ds_read_b64_tr_b16 v[102:103], v29 offset:41728
    v_mfma_f32_16x16x32_bf16 v[68:71], v[120:123], v[128:131], v[68:71]
    ds_read_b64_tr_b16 v[104:105], v30 offset:40960
    ds_read_b64_tr_b16 v[106:107], v30 offset:41728
    ds_read_b64_tr_b16 v[108:109], v31 offset:40960
    v_mfma_f32_16x16x32_bf16 v[72:75], v[120:123], v[132:135], v[72:75]
    ds_read_b64_tr_b16 v[110:111], v31 offset:41728
    ds_read_b64_tr_b16 v[112:113], v32 offset:40960
    ds_read_b64_tr_b16 v[114:115], v32 offset:41728
    v_mfma_f32_16x16x32_bf16 v[76:79], v[120:123], v[136:139], v[76:79]
    ds_read_b64_tr_b16 v[116:117], v33 offset:40960
    ds_read_b64_tr_b16 v[118:119], v33 offset:41728
    v_mfma_f32_16x16x32_bf16 v[80:83], v[120:123], v[140:143], v[80:83]
    s_waitcnt lgkmcnt(0)
    v_mfma_f32_16x16x32_bf16 v[64:67], v[96:99], v[100:103], v[64:67]
    ds_read_b128 v[120:123], v21 offset:40960
    ds_read_b64_tr_b16 v[124:125], v29 offset:47104
    ds_read_b64_tr_b16 v[126:127], v29 offset:47872
    v_mfma_f32_16x16x32_bf16 v[68:71], v[96:99], v[104:107], v[68:71]
    ds_read_b64_tr_b16 v[128:129], v30 offset:47104
    ds_read_b64_tr_b16 v[130:131], v30 offset:47872
    ds_read_b64_tr_b16 v[132:133], v31 offset:47104
    v_mfma_f32_16x16x32_bf16 v[72:75], v[96:99], v[108:111], v[72:75]
    ds_read_b64_tr_b16 v[134:135], v31 offset:47872
    ds_read_b64_tr_b16 v[136:137], v32 offset:47104
    ds_read_b64_tr_b16 v[138:139], v32 offset:47872
    v_mfma_f32_16x16x32_bf16 v[76:79], v[96:99], v[112:115], v[76:79]
    ds_read_b64_tr_b16 v[140:141], v33 offset:47104
    ds_read_b64_tr_b16 v[142:143], v33 offset:47872
    v_mfma_f32_16x16x32_bf16 v[80:83], v[96:99], v[116:119], v[80:83]
    s_waitcnt lgkmcnt(0)
    v_mfma_f32_16x16x32_bf16 v[64:67], v[120:123], v[124:127], v[64:67]
    ds_read_b128 v[96:99], v22 offset:40960
    ds_read_b64_tr_b16 v[100:101], v29 offset:53248
    ds_read_b64_tr_b16 v[102:103], v29 offset:54016
    v_mfma_f32_16x16x32_bf16 v[68:71], v[120:123], v[128:131], v[68:71]
    ds_read_b64_tr_b16 v[104:105], v30 offset:53248
    ds_read_b64_tr_b16 v[106:107], v30 offset:54016
    ds_read_b64_tr_b16 v[108:109], v31 offset:53248
    v_mfma_f32_16x16x32_bf16 v[72:75], v[120:123], v[132:135], v[72:75]
    ds_read_b64_tr_b16 v[110:111], v31 offset:54016
    ds_read_b64_tr_b16 v[112:113], v32 offset:53248
    ds_read_b64_tr_b16 v[114:115], v32 offset:54016
    v_mfma_f32_16x16x32_bf16 v[76:79], v[120:123], v[136:139], v[76:79]
    ds_read_b64_tr_b16 v[116:117], v33 offset:53248
    ds_read_b64_tr_b16 v[118:119], v33 offset:54016
    v_mfma_f32_16x16x32_bf16 v[80:83], v[120:123], v[140:143], v[80:83]
    s_waitcnt lgkmcnt(0)
    v_mfma_f32_16x16x32_bf16 v[64:67], v[96:99], v[100:103], v[64:67]
    ds_read_b128 v[120:123], v23 offset:40960
    ds_read_b64_tr_b16 v[124:125], v29 offset:59392
    ds_read_b64_tr_b16 v[126:127], v29 offset:60160
    v_mfma_f32_16x16x32_bf16 v[68:71], v[96:99], v[104:107], v[68:71]
    ds_read_b64_tr_b16 v[128:129], v30 offset:59392
    ds_read_b64_tr_b16 v[130:131], v30 offset:60160
    ds_read_b64_tr_b16 v[132:133], v31 offset:59392
    v_mfma_f32_16x16x32_bf16 v[72:75], v[96:99], v[108:111], v[72:75]
    ds_read_b64_tr_b16 v[134:135], v31 offset:60160
    ds_read_b64_tr_b16 v[136:137], v32 offset:59392
    ds_read_b64_tr_b16 v[138:139], v32 offset:60160
    v_mfma_f32_16x16x32_bf16 v[76:79], v[96:99], v[112:115], v[76:79]
    ds_read_b64_tr_b16 v[140:141], v33 offset:59392
    ds_read_b64_tr_b16 v[142:143], v33 offset:60160
    v_mfma_f32_16x16x32_bf16 v[80:83], v[96:99], v[116:119], v[80:83]
    s_waitcnt lgkmcnt(0)
    s_waitcnt vmcnt(0)
    s_barrier
    v_mfma_f32_16x16x32_bf16 v[64:67], v[120:123], v[124:127], v[64:67]
    ds_read_b128 v[96:99], v16 offset:0
    ds_read_b64_tr_b16 v[100:101], v24 offset:0
    ds_read_b64_tr_b16 v[102:103], v24 offset:768
    v_mfma_f32_16x16x32_bf16 v[68:71], v[120:123], v[128:131], v[68:71]
    ds_read_b64_tr_b16 v[104:105], v25 offset:0
    ds_read_b64_tr_b16 v[106:107], v25 offset:768
    ds_read_b64_tr_b16 v[108:109], v26 offset:0
    v_mfma_f32_16x16x32_bf16 v[72:75], v[120:123], v[132:135], v[72:75]
    ds_read_b64_tr_b16 v[110:111], v26 offset:768
    ds_read_b64_tr_b16 v[112:113], v27 offset:0
    ds_read_b64_tr_b16 v[114:115], v27 offset:768
    v_mfma_f32_16x16x32_bf16 v[76:79], v[120:123], v[136:139], v[76:79]
    ds_read_b64_tr_b16 v[116:117], v28 offset:0
    ds_read_b64_tr_b16 v[118:119], v28 offset:768
    v_mfma_f32_16x16x32_bf16 v[80:83], v[120:123], v[140:143], v[80:83]
    s_waitcnt lgkmcnt(0)
    v_mfma_f32_16x16x32_bf16 v[64:67], v[96:99], v[100:103], v[64:67]
    ds_read_b128 v[120:123], v17 offset:0
    ds_read_b64_tr_b16 v[124:125], v24 offset:6144
    ds_read_b64_tr_b16 v[126:127], v24 offset:6912
    v_mfma_f32_16x16x32_bf16 v[68:71], v[96:99], v[104:107], v[68:71]
    ds_read_b64_tr_b16 v[128:129], v25 offset:6144
    ds_read_b64_tr_b16 v[130:131], v25 offset:6912
    ds_read_b64_tr_b16 v[132:133], v26 offset:6144
    v_mfma_f32_16x16x32_bf16 v[72:75], v[96:99], v[108:111], v[72:75]
    ds_read_b64_tr_b16 v[134:135], v26 offset:6912
    ds_read_b64_tr_b16 v[136:137], v27 offset:6144
    ds_read_b64_tr_b16 v[138:139], v27 offset:6912
    v_mfma_f32_16x16x32_bf16 v[76:79], v[96:99], v[112:115], v[76:79]
    ds_read_b64_tr_b16 v[140:141], v28 offset:6144
    ds_read_b64_tr_b16 v[142:143], v28 offset:6912
    v_mfma_f32_16x16x32_bf16 v[80:83], v[96:99], v[116:119], v[80:83]
    s_waitcnt lgkmcnt(0)
    v_mfma_f32_16x16x32_bf16 v[64:67], v[120:123], v[124:127], v[64:67]
    ds_read_b128 v[96:99], v18 offset:0
    ds_read_b64_tr_b16 v[100:101], v24 offset:12288
    ds_read_b64_tr_b16 v[102:103], v24 offset:13056
    v_mfma_f32_16x16x32_bf16 v[68:71], v[120:123], v[128:131], v[68:71]
    ds_read_b64_tr_b16 v[104:105], v25 offset:12288
    ds_read_b64_tr_b16 v[106:107], v25 offset:13056
    ds_read_b64_tr_b16 v[108:109], v26 offset:12288
    v_mfma_f32_16x16x32_bf16 v[72:75], v[120:123], v[132:135], v[72:75]
    ds_read_b64_tr_b16 v[110:111], v26 offset:13056
    ds_read_b64_tr_b16 v[112:113], v27 offset:12288
    ds_read_b64_tr_b16 v[114:115], v27 offset:13056
    v_mfma_f32_16x16x32_bf16 v[76:79], v[120:123], v[136:139], v[76:79]
    ds_read_b64_tr_b16 v[116:117], v28 offset:12288
    ds_read_b64_tr_b16 v[118:119], v28 offset:13056
    v_mfma_f32_16x16x32_bf16 v[80:83], v[120:123], v[140:143], v[80:83]
    s_waitcnt lgkmcnt(0)
    v_mfma_f32_16x16x32_bf16 v[64:67], v[96:99], v[100:103], v[64:67]
    ds_read_b128 v[120:123], v19 offset:0
    ds_read_b64_tr_b16 v[124:125], v24 offset:18432
    ds_read_b64_tr_b16 v[126:127], v24 offset:19200
    v_mfma_f32_16x16x32_bf16 v[68:71], v[96:99], v[104:107], v[68:71]
    ds_read_b64_tr_b16 v[128:129], v25 offset:18432
    ds_read_b64_tr_b16 v[130:131], v25 offset:19200
    ds_read_b64_tr_b16 v[132:133], v26 offset:18432
    v_mfma_f32_16x16x32_bf16 v[72:75], v[96:99], v[108:111], v[72:75]
    ds_read_b64_tr_b16 v[134:135], v26 offset:19200
    ds_read_b64_tr_b16 v[136:137], v27 offset:18432
    ds_read_b64_tr_b16 v[138:139], v27 offset:19200
    v_mfma_f32_16x16x32_bf16 v[76:79], v[96:99], v[112:115], v[76:79]
    ds_read_b64_tr_b16 v[140:141], v28 offset:18432
    ds_read_b64_tr_b16 v[142:143], v28 offset:19200
    v_mfma_f32_16x16x32_bf16 v[80:83], v[96:99], v[116:119], v[80:83]
    s_waitcnt lgkmcnt(0)
    v_mfma_f32_16x16x32_bf16 v[64:67], v[120:123], v[124:127], v[64:67]
    v_mfma_f32_16x16x32_bf16 v[68:71], v[120:123], v[128:131], v[68:71]
    v_mfma_f32_16x16x32_bf16 v[72:75], v[120:123], v[132:135], v[72:75]
    v_mfma_f32_16x16x32_bf16 v[76:79], v[120:123], v[136:139], v[76:79]
    v_mfma_f32_16x16x32_bf16 v[80:83], v[120:123], v[140:143], v[80:83]
    s_nop 7
    s_nop 1
    s_barrier
    v_and_b32 v2, 15, v1
    v_lshrrev_b32 v3, 4, v1
    s_lshl_b32 s32, s24, 4
    v_lshl_add_u32 v8, v3, 2, s32
    v_mul_u32_u24 v8, 176, v8
    v_lshl_add_u32 v8, v2, 1, v8
    v_cvt_pk_bf16_f32 v96, v64, v65
    v_cvt_pk_bf16_f32 v97, v66, v67
    v_cvt_pk_bf16_f32 v98, v68, v69
    v_cvt_pk_bf16_f32 v99, v70, v71
    v_cvt_pk_bf16_f32 v100, v72, v73
    v_cvt_pk_bf16_f32 v101, v74, v75
    v_cvt_pk_bf16_f32 v102, v76, v77
    v_cvt_pk_bf16_f32 v103, v78, v79
    v_cvt_pk_bf16_f32 v104, v80, v81
    v_cvt_pk_bf16_f32 v105, v82, v83
    ds_write_b16 v8, v96 offset:0
    ds_write_b16_d16_hi v8, v96 offset:176
    ds_write_b16 v8, v97 offset:352
    ds_write_b16_d16_hi v8, v97 offset:528
    ds_write_b16 v8, v98 offset:32
    ds_write_b16_d16_hi v8, v98 offset:208
    ds_write_b16 v8, v99 offset:384
    ds_write_b16_d16_hi v8, v99 offset:560
    ds_write_b16 v8, v100 offset:64
    ds_write_b16_d16_hi v8, v100 offset:240
    ds_write_b16 v8, v101 offset:416
    ds_write_b16_d16_hi v8, v101 offset:592
    ds_write_b16 v8, v102 offset:96
    ds_write_b16_d16_hi v8, v102 offset:272
    ds_write_b16 v8, v103 offset:448
    ds_write_b16_d16_hi v8, v103 offset:624
    ds_write_b16 v8, v104 offset:128
    ds_write_b16_d16_hi v8, v104 offset:304
    ds_write_b16 v8, v105 offset:480
    ds_write_b16_d16_hi v8, v105 offset:656
    s_waitcnt lgkmcnt(0)
    v_add_u32 v10, 0, v1
    v_mul_u32_u24 v11, 0x199a, v10
    v_lshrrev_b32 v11, 16, v11
    v_mul_u32_u24 v2, 10, v11
    v_sub_u32 v2, v10, v2
    v_add_u32 v3, s32, v11
    v_mul_u32_u24 v8, 176, v3
    v_lshl_add_u32 v8, v2, 4, v8
    ds_read_b128 v[120:123], v8
    s_lshl_b32 s33, s25, 6
    v_add_u32 v3, s33, v3
    v_mul_u32_u24 v3, 1280, v3
    v_lshl_add_u32 v3, v2, 4, v3
    s_mul_i32 s33, s26, 160
    v_add_u32 v136, s33, v3
    v_add_u32 v10, 64, v1
    v_mul_u32_u24 v11, 0x199a, v10
    v_lshrrev_b32 v11, 16, v11
    v_mul_u32_u24 v2, 10, v11
    v_sub_u32 v2, v10, v2
    v_add_u32 v3, s32, v11
    v_mul_u32_u24 v8, 176, v3
    v_lshl_add_u32 v8, v2, 4, v8
    ds_read_b128 v[124:127], v8
    s_lshl_b32 s33, s25, 6
    v_add_u32 v3, s33, v3
    v_mul_u32_u24 v3, 1280, v3
    v_lshl_add_u32 v3, v2, 4, v3
    s_mul_i32 s33, s26, 160
    v_add_u32 v137, s33, v3
    v_add_u32 v10, 128, v1
    v_mul_u32_u24 v11, 0x199a, v10
    v_lshrrev_b32 v11, 16, v11
    v_mul_u32_u24 v2, 10, v11
    v_sub_u32 v2, v10, v2
    v_add_u32 v3, s32, v11
    v_mul_u32_u24 v8, 176, v3
    v_lshl_add_u32 v8, v2, 4, v8
    v_cmp_gt_u32 vcc, 32, v1
    s_and_saveexec_b64 s[36:37], vcc
    ds_read_b128 v[128:131], v8
    s_lshl_b32 s33, s25, 6
    v_add_u32 v3, s33, v3
    v_mul_u32_u24 v3, 1280, v3
    v_lshl_add_u32 v3, v2, 4, v3
    s_mul_i32 s33, s26, 160
    v_add_u32 v138, s33, v3
    s_mov_b64 exec, s[36:37]
    s_waitcnt lgkmcnt(0)
    buffer_store_dwordx4 v[120:123], v136, s[12:15], 0 offen
    buffer_store_dwordx4 v[124:127], v137, s[12:15], 0 offen
    v_cmp_gt_u32 vcc, 32, v1
    s_and_saveexec_b64 s[36:37], vcc
    buffer_store_dwordx4 v[128:131], v138, s[12:15], 0 offen
    s_mov_b64 exec, s[36:37]
    s_waitcnt vmcnt(0)
K3_END:
    s_endpgm
.section .rodata,"a"
.p2align 6
.amdhsa_kernel k1_kernel
  .amdhsa_next_free_vgpr 160
  .amdhsa_next_free_sgpr 96
  .amdhsa_accum_offset 160
  .amdhsa_group_segment_fixed_size 0
  .amdhsa_kernarg_size 48
  .amdhsa_user_sgpr_count 2
  .amdhsa_user_sgpr_kernarg_segment_ptr 1
  .amdhsa_system_sgpr_workgroup_id_x 1
.end_amdhsa_kernel
.p2align 6
.amdhsa_kernel k2_kernel
  .amdhsa_next_free_vgpr 248
  .amdhsa_next_free_sgpr 96
  .amdhsa_accum_offset 248
  .amdhsa_group_segment_fixed_size 0
  .amdhsa_kernarg_size 48
  .amdhsa_user_sgpr_count 2
  .amdhsa_user_sgpr_kernarg_segment_ptr 1
  .amdhsa_system_sgpr_workgroup_id_x 1
.end_amdhsa_kernel
.p2align 6
.amdhsa_kernel k3_kernel
  .amdhsa_next_free_vgpr 144
  .amdhsa_next_free_sgpr 96
  .amdhsa_accum_offset 144
  .amdhsa_group_segment_fixed_size 0
  .amdhsa_kernarg_size 48
  .amdhsa_user_sgpr_count 2
  .amdhsa_user_sgpr_kernarg_segment_ptr 1
  .amdhsa_system_sgpr_workgroup_id_x 1
.end_amdhsa_kernel
```
